```python
import torch

def _softmax(x, axis=-1):
    return torch.softmax(x, dim=axis)
def _gelu(x):
    return torch.nn.functional.gelu(x, approximate="tanh")
def _silu(x):
    return torch.nn.functional.silu(x)
def _sigmoid(x):
    return torch.sigmoid(x)
def _layernorm(x, axis=-1, eps=1e-5):
    m = x.mean(dim=axis, keepdim=True)
    v = x.var(dim=axis, keepdim=True, unbiased=False)
    return (x - m) / torch.sqrt(v + eps)
def _scatter_add(tgt, idx, src, axis=0):
    return tgt.clone().index_add_(axis, idx, src)
def _segment_sum(src, seg, n):
    out = torch.zeros((n,) + src.shape[1:], dtype=src.dtype)
    return out.index_add_(0, seg, src)
def _pad(x, pw):
    flat = tuple(v for pair in reversed(pw) for v in pair)
    return torch.nn.functional.pad(x, flat)

kernel_name = 'interleave_layers__sliding_block_cached__dense_activation_silu__decode'

def setup_inputs():

    _w = (lambda a: (lambda t: t.to(torch.bfloat16) if t.is_floating_point() else t)(torch.as_tensor(a)))
    def _A_setup():
        B, Sq, D = 1, 1, 512
        Hq, Hkv, Sk, Dh = 32, 8, 16384, 128
        assert Hq % Hkv == 0, (Hq, Hkv)
        return {
            "x": _w((lambda *s: torch.randn(*s, dtype=torch.bfloat16) * 0.05)(B, Sq, D)),
            "k_cache": _w((lambda *s: torch.randn(*s, dtype=torch.bfloat16) * 0.8)(B, Hkv, Sk, Dh)),
            "v_cache": _w((lambda *s: torch.randn(*s, dtype=torch.bfloat16) * 1.6)(B, Hkv, Sk, Dh)),
            "wq": _w((lambda *s: torch.randn(*s, dtype=torch.bfloat16) * 0.8)(D, Hq * Dh) * (D ** -0.5)),
            "wo": _w((lambda *s: torch.randn(*s, dtype=torch.bfloat16) * 1.6)(Hq * Dh, D) * ((Hq * Dh) ** -0.5)),
        }
    _A_in = _A_setup()

    def _B_setup():
        B, S, D, F = 1, 1, 512, 1792
        return {
            "x": _w((lambda *s: torch.randn(*s, dtype=torch.bfloat16) * 0.05)(B, S, D)),
            "w1": _w((lambda *s: torch.randn(*s, dtype=torch.bfloat16) * 0.4)(D, F) * (D ** -0.5)),
            "w2": _w((lambda *s: torch.randn(*s, dtype=torch.bfloat16) * 0.4)(F, D) * (F ** -0.5)),
        }
    _B_in = _B_setup()

    return {
        "A_x": _A_in["x"],
        "A_k_cache": _A_in["k_cache"],
        "A_v_cache": _A_in["v_cache"],
        "A_wq": _A_in["wq"],
        "A_wo": _A_in["wo"],
        "B_x": _B_in["x"],
        "B_w1": _B_in["w1"],
        "B_w2": _B_in["w2"],
    }

def reference(A_x, A_k_cache, A_v_cache, A_wq, A_wo, B_x, B_w1, B_w2):
    def _A_ref(x, k_cache, v_cache, wq, wo):
        B, Sq, D = x.shape
        Hq, Dh = 32, 128
        Hkv, Sk = k_cache.shape[1], k_cache.shape[2]
        W = min(4096, max(256, Sk // 4))
        rep = Hq // Hkv
        q = (lambda x, *d: x.permute(*d))((x @ wq).reshape(B, Sq, Hq, Dh), 0, 2, 1, 3)
        k = (lambda x, n, axis: torch.repeat_interleave(x, n, dim=axis))(k_cache[:, :, Sk - W:, :], rep, axis=1)
        v = (lambda x, n, axis: torch.repeat_interleave(x, n, dim=axis))(v_cache[:, :, Sk - W:, :], rep, axis=1)
        scores = torch.einsum("bhqd,bhkd->bhqk", q, k) * (Dh ** -0.5)
        p = _softmax(scores, axis=-1)
        o = torch.einsum("bhqk,bhkd->bhqd", p, v)
        return (lambda x, *d: x.permute(*d))(o, 0, 2, 1, 3).reshape(B, Sq, Hq * Dh) @ wo

    def _B_ref(x, w1, w2):
        h = torch.einsum("bsd,df->bsf", x, w1)
        h = _silu(h)
        out = torch.einsum("bsf,fd->bsd", h, w2)
        return out

    x = A_x
    x = x + _A_ref(_layernorm(x, axis=-1), A_k_cache, A_v_cache, A_wq, A_wo)
    x = x + _B_ref(_layernorm(x, axis=-1), B_w1, B_w2)
    x = x + _A_ref(_layernorm(x, axis=-1), A_k_cache, A_v_cache, A_wq, A_wo)
    x = x + _B_ref(_layernorm(x, axis=-1), B_w1, B_w2)
    return x
```

```asm
; @launch grid=(256,1,1) block=(320,1,1) lds=131072
.amdgcn_target "amdgcn-amd-amdhsa--gfx950"
.text
.globl interleave_layers__sliding_block_cached__dense_activation_silu__decode_kernel
.p2align 8
.type interleave_layers__sliding_block_cached__dense_activation_silu__decode_kernel,@function
interleave_layers__sliding_block_cached__dense_activation_silu__decode_kernel:
    s_cmp_ge_u32 s2, 256
    s_cbranch_scc1 .Lend
    s_load_dwordx8 s[40:47], s[0:1], 0
    s_load_dwordx2 s[84:85], s[0:1], 80
    s_load_dwordx2 s[48:49], s[0:1], 32
    v_lshrrev_b32 v228, 6, v0
    v_and_b32 v1, 63, v0
    s_and_b32 s20, s2, 7
    s_lshr_b32 s21, s2, 3
    v_readfirstlane_b32 s22, v228
    s_cmp_lg_u32 s22, 0
    s_cbranch_scc1 .Lcompute
    s_setprio 3
    s_and_b32 s36, s21, 3
    s_lshl_b32 s36, s36, 20
    s_lshr_b32 s37, s21, 2
    s_lshl_b32 s37, s37, 7
    s_add_u32 s36, s36, s37
    s_lshl_b32 s37, s20, 10
    s_add_u32 s36, s36, s37
    v_lshrrev_b32 v52, 3, v1
    v_lshlrev_b32 v52, 13, v52
    v_and_b32 v53, 7, v1
    v_bfe_u32 v50, v1, 4, 1
    v_lshlrev_b32 v50, 1, v50
    v_xor_b32 v53, v53, v50
    v_lshl_add_u32 v52, v53, 4, v52
    v_add_u32 v40, s36, v52
    v_xor_b32 v41, 64, v40
    v_add_u32 v42, 129024, v40
    v_add_u32 v43, 193536, v41
    v_add_u32 v41, 64512, v41
    s_mov_b32 s10, 0x400000
    s_mov_b32 s11, 0x20000
    s_mov_b32 s37, 0
    s_mov_b32 m0, 16384
    s_lshl_b32 s38, s20, 22
    s_lshl_b32 s36, s21, 15
    s_add_u32 s38, s38, s36
    s_add_u32 s38, s38, 3145728
    s_mov_b32 s14, 0x2000000
    s_mov_b32 s15, 0x20000
    s_mov_b32 s62, 0x2000000
    s_mov_b32 s63, 0x20000
    s_waitcnt lgkmcnt(0)
    s_mov_b32 s8, s46
    s_mov_b32 s9, s47
.Lwq:
    buffer_load_dwordx4 v40, s[8:11], s37 offen offset:0 nt lds
    buffer_load_dwordx4 v41, s[8:11], s37 offen offset:1024 nt lds
    buffer_load_dwordx4 v42, s[8:11], s37 offen offset:2048 nt lds
    buffer_load_dwordx4 v43, s[8:11], s37 offen offset:3072 nt lds
    s_add_u32 m0, m0, 4096
    s_add_u32 s37, s37, 0x40000
    s_cmp_lt_u32 s37, 0x100000
    s_cbranch_scc1 .Lwq
    s_load_dwordx4 s[52:55], s[0:1], 48
    s_mov_b32 s12, s42
    s_mov_b32 s13, s43
    v_lshrrev_b32 v50, 4, v1
    v_and_b32 v51, 15, v1
    v_xor_b32 v52, v51, v50
    v_lshlrev_b32 v52, 4, v52
    v_lshl_add_u32 v52, v50, 8, v52
    v_add_u32 v44, s38, v52
    v_xor_b32 v45, 64, v44
    v_xor_b32 v46, 128, v44
    v_xor_b32 v47, 192, v44
    s_lshl_b32 s37, s20, 12
    s_mov_b32 s33, 0
    s_mov_b32 s34, 32768
.Lkv:
    s_add_u32 m0, s37, s34
    s_add_u32 s33, s33, 1
    buffer_load_dwordx4 v44, s[12:15], s37 offen offset:0 nt lds
    s_waitcnt vmcnt(16)
    buffer_load_dwordx4 v45, s[12:15], s37 offen offset:1024 nt lds
    s_waitcnt vmcnt(16)
    buffer_load_dwordx4 v46, s[12:15], s37 offen offset:2048 nt lds
    s_waitcnt vmcnt(16)
    buffer_load_dwordx4 v47, s[12:15], s37 offen offset:3072 nt lds
    s_waitcnt vmcnt(16)
    s_add_u32 s37, s37, 4096
    s_and_b32 s37, s37, 0x7fff
    s_cmp_eq_u32 s33, 4
    s_cbranch_scc1 .Lm1
    s_cmp_eq_u32 s33, 8
    s_cbranch_scc1 .Lm2
    s_cmp_eq_u32 s33, 12
    s_cbranch_scc1 .Lm3
.Lm4:
    s_cmp_lt_u32 s33, 16
    s_cbranch_scc1 .Lkv
    s_branch .Lw3
.Lm1:
    s_barrier
    s_branch .Lkv
.Lm2:
    v_lshlrev_b32 v52, 1, v50
    v_xor_b32 v52, v51, v52
    v_lshlrev_b32 v52, 4, v52
    v_lshl_add_u32 v52, v50, 8, v52
    v_add_u32 v44, s38, v52
    v_xor_b32 v45, 128, v44
    v_mov_b32 v46, v44
    v_mov_b32 v47, v45
    s_mov_b32 s12, s44
    s_mov_b32 s13, s45
    s_mov_b32 s34, 65536
    s_branch .Lkv
.Lm3:
    v_mov_b32 v58, 0
    v_mov_b32 v59, 1
    ds_write_b32 v58, v59 offset:2448
    s_branch .Lm4
.Lw3:
    s_mov_b32 s16, s84
    s_mov_b32 s17, s85
    s_mov_b32 s18, 0x10000000
    s_mov_b32 s19, 0x20000
    v_lshlrev_b32 v40, 4, v1
    v_xor_b32 v41, 32, v40
    v_xor_b32 v42, 64, v40
    v_xor_b32 v43, 96, v40
    s_waitcnt lgkmcnt(0)
    s_cmp_lt_u32 s21, 14
    s_cbranch_scc1 .Lldf
    s_mov_b32 s88, s48
    s_mov_b32 s89, s49
    s_mov_b32 s90, 0x400000
    s_mov_b32 s91, 0x20000
    s_lshl_b32 s37, s20, 19
    s_and_b32 s36, s21, 15
    s_lshl_b32 s36, s36, 15
    s_add_u32 s37, s37, s36
    s_mov_b32 m0, 98304
    s_mov_b32 s33, 0
.Lwo:
    buffer_load_dwordx4 v40, s[88:91], s37 offen offset:0 nt lds
    s_waitcnt vmcnt(16)
    buffer_load_dwordx4 v41, s[88:91], s37 offen offset:1024 nt lds
    s_waitcnt vmcnt(16)
    buffer_load_dwordx4 v42, s[88:91], s37 offen offset:2048 nt lds
    s_waitcnt vmcnt(16)
    buffer_load_dwordx4 v43, s[88:91], s37 offen offset:3072 nt lds
    s_waitcnt vmcnt(16)
    s_add_u32 m0, m0, 4096
    s_add_u32 s37, s37, 4096
    s_lshl_b32 s36, s33, 7
    s_and_b32 s36, s36, 128
    s_add_u32 s33, s33, 1
    v_xor_b32 v40, s36, v40
    v_xor_b32 v41, s36, v41
    v_xor_b32 v42, s36, v42
    v_xor_b32 v43, s36, v43
    s_cmp_lg_u32 s33, 4
    s_cbranch_scc1 .Lwon
    s_barrier
.Lwon:
    s_cmp_lt_u32 s33, 8
    s_cbranch_scc1 .Lwo
    s_barrier
    s_branch .Lldj
.Lldf:
    s_mov_b32 s88, s52
    s_mov_b32 s89, s53
    s_mov_b32 s90, 0x1c0000
    s_mov_b32 s91, 0x20000
    s_mov_b32 s92, s54
    s_mov_b32 s93, s55
    s_mov_b32 s94, 0x1c0000
    s_mov_b32 s95, 0x20000
    s_mul_i32 s38, s20, 14
    s_add_u32 s38, s38, s21
    s_lshl_b32 s37, s38, 14
    s_lshl_b32 s38, s38, 5
    v_lshrrev_b32 v44, 1, v1
    s_movk_i32 s36, 3584
    v_mul_lo_u32 v44, v44, s36
    v_and_b32 v45, 1, v1
    v_lshl_add_u32 v44, v45, 4, v44
    v_add_u32 v44, s38, v44
    v_add_u32 v45, 113664, v44
    v_add_u32 v46, 227328, v44
    v_add_u32 v47, 340992, v44
    s_waitcnt vmcnt(0)
    s_barrier
    s_barrier
    s_mov_b32 m0, 114688
    s_mov_b32 s33, 0
.Lw2:
    buffer_load_dwordx4 v40, s[92:95], s37 offen offset:0 nt lds
    buffer_load_dwordx4 v41, s[92:95], s37 offen offset:1024 nt lds
    buffer_load_dwordx4 v42, s[92:95], s37 offen offset:2048 nt lds
    buffer_load_dwordx4 v43, s[92:95], s37 offen offset:3072 nt lds
    s_add_u32 m0, m0, 4096
    s_add_u32 s37, s37, 4096
    s_lshl_b32 s36, s33, 7
    s_and_b32 s36, s36, 128
    s_add_u32 s33, s33, 1
    v_xor_b32 v40, s36, v40
    v_xor_b32 v41, s36, v41
    v_xor_b32 v42, s36, v42
    v_xor_b32 v43, s36, v43
    s_cmp_lt_u32 s33, 4
    s_cbranch_scc1 .Lw2
    s_mov_b32 m0, 98304
    s_mov_b32 s37, 0
.Lw1:
    buffer_load_dwordx4 v44, s[88:91], s37 offen offset:0  lds
    buffer_load_dwordx4 v45, s[88:91], s37 offen offset:1024  lds
    buffer_load_dwordx4 v46, s[88:91], s37 offen offset:2048  lds
    buffer_load_dwordx4 v47, s[88:91], s37 offen offset:3072  lds
    s_add_u32 m0, m0, 4096
    s_add_u32 s37, s37, 458752
    s_cmp_lt_u32 s37, 1835008
    s_cbranch_scc1 .Lw1
.Lldj:
    s_waitcnt vmcnt(0)
    s_barrier
    s_movk_i32 s22, 4
    s_branch .Lexit
.Lcompute:
    s_load_dwordx4 s[80:83], s[0:1], 64
    s_sub_u32 s22, s22, 1
    s_and_b32 s23, s21, 3
    s_getpc_b64 s[92:93]
.Lpc:
    s_lshl_b32 s37, s21, 2
    s_add_u32 s37, s37, s22
    s_lshl_b32 s37, s37, 7
    s_add_u32 s38, s37, 64
    s_min_u32 s37, s37, .Lend-.Lpc
    s_min_u32 s38, s38, .Lend-.Lpc
    v_lshrrev_b32 v229, 4, v1
    s_lshl_b32 s36, s23, 8
    v_lshl_add_u32 v229, v229, 4, s36
    v_lshlrev_b32 v228, 4, v1
    s_waitcnt lgkmcnt(0)
    s_load_dword s27, s[84:85], 0
    s_load_dword s94, s[92:93], s37
    s_load_dword s95, s[92:93], s38
    s_mov_b32 s88, s40
    s_mov_b32 s89, s41
    s_mov_b32 s90, 0x400
    s_mov_b32 s91, 0x20000
    buffer_load_dwordx4 v[56:59], v228, s[88:91], 0 offen
    v_mov_b32 v60, v228
    v_mov_b32 v61, v229
    s_mov_b32 s16, s84
    s_mov_b32 s17, s85
    s_mov_b32 s18, 0x10000000
    s_mov_b32 s19, 0x20000
    s_mov_b32 s8, s84
    s_mov_b32 s9, s85
    s_mov_b32 s10, 0x0
    s_mov_b32 s11, 0x20000
    s_mov_b32 s12, s84
    s_mov_b32 s13, s85
    s_mov_b32 s14, 0x10000000
    s_mov_b32 s15, 0x20000
    s_getreg_b32 s26, hwreg(HW_REG_XCC_ID, 0, 4)
    s_mov_b32 s25, 0x3f803f80
    v_lshrrev_b32 v228, 4, v1
    v_and_b32 v229, 15, v1
    v_and_b32 v230, 3, v1
    v_and_b32 v231, 31, v1
    v_lshrrev_b32 v232, 5, v1
    v_mov_b32 v2, 0xfffffc00
    s_lshr_b32 s33, s21, 2
    v_mov_b32 v19, 0
    s_mov_b32 s31, 65536
    s_mov_b32 s60, 69632
    s_lshl_b32 s34, s20, 13
    s_lshl_b32 s36, s23, 11
    s_add_u32 s36, s36, s34
    s_lshl_b32 s37, s33, 8
    s_add_u32 s36, s36, s37
    s_lshl_b32 s37, s22, 6
    s_add_u32 s36, s36, s37
    v_lshl_add_u32 v4, v1, 2, s36
    v_cmp_gt_u32 vcc, 16, v1
    v_mov_b32 v235, 0x80000000
    s_nop 0
    v_cndmask_b32 v4, v235, v4, vcc
    s_lshl_b32 s37, s22, 9
    s_add_u32 s36, s34, s37
    v_lshl_add_u32 v233, v232, 11, s36
    v_lshl_add_u32 v6, v231, 4, v233
    s_lshl_b32 s35, s20, 12
    s_add_u32 s35, s35, 131072
    s_lshl_b32 s36, s23, 10
    s_add_u32 s36, s36, s35
    s_lshl_b32 s37, s33, 7
    s_add_u32 s36, s36, s37
    s_lshl_b32 s37, s22, 4
    s_add_u32 s36, s36, s37
    v_mov_b32 v5, s36
    v_cmp_eq_u32 vcc, 0, v1
    v_mov_b32 v235, 0x80000000
    s_nop 0
    v_cndmask_b32 v5, v235, v5, vcc
    s_lshl_b32 s37, s22, 8
    s_add_u32 s36, s35, s37
    v_lshl_add_u32 v233, v230, 10, s36
    v_bfe_u32 v234, v1, 2, 2
    v_lshl_add_u32 v7, v234, 4, v233
    v_and_b32 v234, 1, v234
    v_lshl_add_u32 v226, v234, 7, v233
    s_bitcmp1_b32 s21, 0
    s_cselect_b32 s36, s60, s31
    s_bitcmp1_b32 s21, 1
    s_cselect_b32 s36, 0, s36
    s_cselect_b64 vcc, -1, 0
    v_cndmask_b32 v228, v6, v226, vcc
    buffer_load_dwordx4 v[144:147], v228, s[16:19], s36 offen
    v_mov_b32 v180, s25
    v_mov_b32 v181, s25
    v_mov_b32 v182, s25
    v_mov_b32 v183, s25
    v_lshlrev_b32 v229, 2, v1
    ds_write_b32 v229, v19 offset:2432
    v_lshrrev_b32 v228, 4, v1
    v_bfe_u32 v229, v1, 2, 2
    v_lshl_add_u32 v230, v228, 3, v229
    v_lshlrev_b32 v230, 7, v230
    v_bfe_u32 v229, v1, 3, 2
    v_xor_b32 v229, s22, v229
    v_lshl_add_u32 v230, v229, 5, v230
    v_and_b32 v229, 3, v1
    v_lshl_add_u32 v228, v229, 3, v230
    s_waitcnt lgkmcnt(0)
    s_add_u32 s64, s27, 1
    s_and_b32 s64, s64, 0x3ff
    s_add_u32 s76, s27, 13
    s_and_b32 s76, s76, 0x3ff
    v_mov_b32 v184, s26
    v_mov_b32 v185, s26
    s_add_u32 s36, s27, 1
    v_mov_b32 v186, s36
    v_mov_b32 v187, s36
    s_waitcnt vmcnt(1)
    ds_write_b128 v60, v[56:59] offset:0
    ds_read_b128 v[152:155], v61 offset:0
    ds_read_b128 v[156:159], v61 offset:64
    ds_read_b128 v[160:163], v61 offset:128
    ds_read_b128 v[164:167], v61 offset:192
    v_dot2_f32_bf16 v176, v56, s25, 0
    v_dot2_f32_bf16 v177, v56, v56, 0
    v_dot2_f32_bf16 v176, v57, s25, v176
    v_dot2_f32_bf16 v177, v57, v57, v177
    v_dot2_f32_bf16 v176, v58, s25, v176
    v_dot2_f32_bf16 v177, v58, v58, v177
    v_dot2_f32_bf16 v176, v59, s25, v176
    v_dot2_f32_bf16 v177, v59, v59, v177
    s_nop 2
    v_permlane32_swap_b32 v176, v177
    v_add_f32 v176, v176, v177
    v_mov_b32 v177, v176
    s_nop 1
    v_permlane16_swap_b32 v176, v177
    v_add_f32 v176, v176, v177
    s_nop 1
    v_add_f32_dpp v176, v176, v176 row_ror:8 row_mask:0xf bank_mask:0xf
    s_nop 1
    v_add_f32_dpp v176, v176, v176 row_ror:4 row_mask:0xf bank_mask:0xf
    s_nop 1
    v_add_f32_dpp v176, v176, v176 row_ror:2 row_mask:0xf bank_mask:0xf
    s_nop 1
    v_add_f32_dpp v176, v176, v176 row_ror:1 row_mask:0xf bank_mask:0xf
    v_mov_b32 v177, v176
    s_nop 1
    v_permlane32_swap_b32 v176, v177
    v_mul_f32 v176, 0x3b000000, v176
    v_mul_f32 v177, 0x3b000000, v177
    v_fma_f32 v177, -v176, v176, v177
    v_max_f32 v177, 0, v177
    v_add_f32 v177, 0x3727c5ac, v177
    v_rsq_f32 v177, v177
    s_barrier
    ds_read_b64_tr_b16 v[40:41], v228 offset:16384
    ds_read_b64_tr_b16 v[42:43], v228 offset:16896
    ds_read_b64_tr_b16 v[44:45], v228 offset:20480
    ds_read_b64_tr_b16 v[46:47], v228 offset:20992
    ds_read_b64_tr_b16 v[48:49], v228 offset:24576
    ds_read_b64_tr_b16 v[50:51], v228 offset:25088
    ds_read_b64_tr_b16 v[52:53], v228 offset:28672
    ds_read_b64_tr_b16 v[54:55], v228 offset:29184
    s_waitcnt lgkmcnt(6)
    v_mfma_f32_16x16x32_bf16 v[168:171], v[152:155], v[40:43], 0
    v_mfma_f32_16x16x32_bf16 v[172:175], v[180:183], v[40:43], 0
    s_waitcnt lgkmcnt(4)
    v_mfma_f32_16x16x32_bf16 v[168:171], v[156:159], v[44:47], v[168:171]
    v_mfma_f32_16x16x32_bf16 v[172:175], v[180:183], v[44:47], v[172:175]
    s_waitcnt lgkmcnt(2)
    v_mfma_f32_16x16x32_bf16 v[168:171], v[160:163], v[48:51], v[168:171]
    v_mfma_f32_16x16x32_bf16 v[172:175], v[180:183], v[48:51], v[172:175]
    s_waitcnt lgkmcnt(0)
    v_mfma_f32_16x16x32_bf16 v[168:171], v[164:167], v[52:55], v[168:171]
    v_mfma_f32_16x16x32_bf16 v[172:175], v[180:183], v[52:55], v[172:175]
    s_nop 7
    v_fma_f32 v168, -v176, v172, v168
    v_mul_f32 v168, v177, v168
    v_bfi_b32 v178, v2, v168, s64
    buffer_store_dword v178, v4, s[16:19], s31 offen
    buffer_store_dwordx4 v[184:187], v5, s[16:19], 0 offen
    v_bfi_b32 v179, v2, v172, s76
    v_lshrrev_b32 v228, 4, v1
    v_and_b32 v229, 15, v1
    v_and_b32 v230, 3, v1
    v_and_b32 v231, 31, v1
    v_lshrrev_b32 v232, 5, v1
    v_mov_b32 v3, 0x3ff
    v_mov_b32 v23, 0x3ff
    v_cmp_gt_u32 vcc, 48, v1
    v_mov_b32 v235, 0x0
    s_nop 0
    v_cndmask_b32 v23, v235, v23, vcc
    s_and_b32 s28, s21, 15
    s_mul_i32 s37, s22, 272
    v_lshl_add_u32 v233, v232, 2, s37
    v_lshl_add_u32 v8, v231, 3, v233
    s_movk_i32 s37, 272
    v_mul_lo_u32 v233, v230, s37
    v_lshl_add_u32 v9, v228, 4, v233
    s_movk_i32 s37, 528
    v_mul_lo_u32 v233, v230, s37
    v_lshl_add_u32 v10, v228, 4, v233
    s_mul_i32 s37, s22, 2112
    v_add_u32 v10, s37, v10
    v_bfe_u32 v233, v1, 2, 2
    v_lshl_add_u32 v10, v233, 6, v10
    s_mov_b32 s48, 0xf000f
    s_mov_b32 s49, 0xf000f
    s_mov_b32 s50, 0xf000f0
    s_mov_b32 s51, 0xf000f0
    s_mov_b32 s52, 0xf000f00
    s_mov_b32 s53, 0xf000f00
    s_mov_b32 s54, 0xf000f000
    s_mov_b32 s55, 0xf000f000
    s_lshl_b32 s37, s22, 3
    v_lshl_add_u32 v11, v230, 5, s37
    v_cmp_gt_u32 vcc, 4, v1
    v_mov_b32 v235, 0x800000
    s_nop 0
    v_cndmask_b32 v11, v235, v11, vcc
    s_mul_i32 s37, s22, 528
    v_lshl_add_u32 v12, v1, 3, s37
    s_lshl_b32 s37, s22, 5
    v_lshl_add_u32 v13, v230, 3, s37
    s_lshl_b32 s34, s20, 16
    s_add_u32 s34, s34, 524288
    s_lshl_b32 s36, s21, 7
    s_add_u32 s36, s36, s34
    s_lshl_b32 s37, s22, 14
    s_add_u32 s36, s36, s37
    v_lshl_add_u32 v233, v228, 12, s36
    v_lshl_add_u32 v14, v229, 3, v233
    s_lshl_b32 s36, s28, 12
    s_add_u32 s36, s36, s34
    s_lshl_b32 s37, s22, 5
    s_add_u32 s36, s36, s37
    v_lshl_add_u32 v233, v232, 4, s36
    v_lshl_add_u32 v16, v231, 7, v233
    s_lshl_b32 s34, s20, 11
    s_add_u32 s34, s34, 262144
    s_lshl_b32 s36, s22, 9
    s_add_u32 s36, s36, s34
    s_lshl_b32 s37, s21, 4
    s_add_u32 s36, s36, s37
    v_mov_b32 v15, s36
    v_cmp_eq_u32 vcc, 0, v1
    v_mov_b32 v235, 0x80000000
    s_nop 0
    v_cndmask_b32 v15, v235, v15, vcc
    s_lshr_b32 s36, s28, 2
    s_lshl_b32 s36, s36, 9
    s_add_u32 s36, s36, s34
    v_lshl_add_u32 v17, v231, 4, s36
    v_bfe_u32 v233, v1, 3, 1
    v_bfe_u32 v234, v1, 4, 1
    v_lshl_add_u32 v233, v233, 1, v234
    v_lshl_add_u32 v233, v232, 2, v233
    s_lshl_b32 s37, s22, 4
    v_lshl_add_u32 v18, v233, 1, s37
    v_and_b32 v234, 7, v1
    v_cmp_eq_u32 vcc, 0, v234
    v_mov_b32 v235, 0x800000
    s_nop 0
    v_cndmask_b32 v18, v235, v18, vcc
    s_lshl_b32 s34, s20, 15
    s_lshl_b32 s36, s28, 7
    s_add_u32 s36, s36, s34
    s_lshl_b32 s37, s22, 13
    s_add_u32 s36, s36, s37
    s_and_b32 s32, s21, 30
    s_cmp_eq_u32 s32, 14
    s_cselect_b32 s32, 0x80000000, 0
    s_or_b32 s36, s36, s32
    v_lshl_add_u32 v233, v232, 11, s36
    v_lshl_add_u32 v20, v231, 2, v233
    s_lshl_b32 s36, s28, 11
    s_add_u32 s36, s36, s34
    v_lshl_add_u32 v21, v1, 4, s36
    v_mov_b32 v22, v21
    v_cmp_gt_u32 vcc, 48, v1
    v_mov_b32 v235, 0x80000000
    s_nop 0
    v_cndmask_b32 v22, v235, v22, vcc
    v_bfe_u32 v234, v1, 4, 1
    v_lshl_add_u32 v236, v234, 1, v232
    v_and_b32 v234, 7, v1
    v_lshl_add_u32 v236, v234, 2, v236
    s_lshr_b32 s36, s28, 2
    s_lshl_b32 s36, s36, 12
    s_lshl_b32 s37, s20, 9
    s_add_u32 s36, s36, s37
    s_and_b32 s37, s28, 3
    s_lshl_b32 s37, s37, 7
    s_add_u32 s36, s36, s37
    s_or_b32 s36, s36, s32
    v_lshl_add_u32 v24, v236, 2, s36
    v_and_b32 v233, 8, v1
    v_cmp_eq_u32 vcc, 0, v233
    v_mov_b32 v235, 0x80000000
    s_nop 0
    v_cndmask_b32 v24, v235, v24, vcc
    s_lshl_b32 s37, s22, 6
    v_lshl_add_u32 v27, v236, 1, s37
    s_lshl_b32 s36, s23, 8
    v_add_u32 v236, s36, v27
    v_cmp_eq_u32 vcc, 0, v233
    v_mov_b32 v235, 0x800000
    s_nop 0
    v_cndmask_b32 v27, v235, v27, vcc
    s_lshl_b32 s36, s23, 12
    s_lshl_b32 s37, s22, 7
    s_add_u32 s36, s36, s37
    v_lshrrev_b32 v233, 3, v1
    v_lshl_add_u32 v233, v233, 9, s36
    v_lshl_add_u32 v25, v234, 4, v233
    s_lshl_b32 s36, s22, 12
    v_lshl_add_u32 v233, v232, 11, s36
    v_lshl_add_u32 v26, v231, 4, v233
    v_lshlrev_b32 v28, 4, v228
    s_lshl_b32 s36, s22, 8
    v_lshl_add_u32 v233, v232, 2, s36
    v_lshl_add_u32 v29, v231, 3, v233
    s_lshl_b32 s36, s22, 2
    v_lshlrev_b32 v31, 4, v229
    v_add_u32 v30, s36, v31
    v_cmp_gt_u32 vcc, 16, v1
    v_mov_b32 v235, 0x800000
    s_nop 0
    v_cndmask_b32 v30, v235, v30, vcc
    v_lshl_add_u32 v32, v232, 4, s36
    v_cmp_eq_u32 vcc, 0, v231
    v_mov_b32 v235, 0x800000
    s_nop 0
    v_cndmask_b32 v32, v235, v32, vcc
    s_mov_b32 s4, 1048576
    s_mov_b32 s5, 1052672
    s_mov_b32 s6, 1310720
    s_mov_b32 s7, 1314816
    s_mov_b32 s29, 196608
    s_mov_b32 s61, 200704
    s_mov_b32 s56, 327680
    s_mov_b32 s57, 344064
    s_mov_b32 s58, 360448
    s_mov_b32 s59, 376832
    s_lshl_b32 s78, s20, 11
    s_add_u32 s78, s78, 393216
    s_cmp_eq_u32 s21, 0
    s_cselect_b32 s79, 0, 0x80000000
    s_mov_b32 s24, 0x3e0293ee
    s_mov_b32 s30, 0x20000
    v_mov_b32 v255, v236
    v_lshlrev_b32 v33, 1, v236
    buffer_load_dword v34, v29, s[88:91], 0 offen
    s_lshr_b32 s36, s2, 5
    s_cmp_eq_u32 s36, 4
    s_cselect_b32 s62, 1, 0
    s_cmp_eq_u32 s20, 0
    s_cselect_b32 s62, s62, 0
    s_add_u32 s65, s27, 2
    s_and_b32 s65, s65, 0x3ff
    s_add_u32 s66, s27, 3
    s_and_b32 s66, s66, 0x3ff
    s_add_u32 s67, s27, 4
    s_and_b32 s67, s67, 0x3ff
    s_add_u32 s68, s27, 5
    s_and_b32 s68, s68, 0x3ff
    s_add_u32 s69, s27, 6
    s_and_b32 s69, s69, 0x3ff
    s_add_u32 s70, s27, 7
    s_and_b32 s70, s70, 0x3ff
    s_add_u32 s71, s27, 8
    s_and_b32 s71, s71, 0x3ff
    s_add_u32 s72, s27, 9
    s_and_b32 s72, s72, 0x3ff
    s_add_u32 s73, s27, 10
    s_and_b32 s73, s73, 0x3ff
    s_add_u32 s74, s27, 11
    s_and_b32 s74, s74, 0x3ff
    s_add_u32 s75, s27, 12
    s_and_b32 s75, s75, 0x3ff
    s_cmp_lt_u32 s21, 16
    s_cbranch_scc1 .Lnowarm
    buffer_load_dwordx4 v[144:147], v16, s[16:19], 0 offen
    s_cmp_eq_u32 s22, 3
    s_cbranch_scc1 .Lnowarm
    s_cmp_eq_u32 s22, 0
    s_cbranch_scc1 .Lwarm0
    s_cmp_eq_u32 s22, 1
    s_cselect_b32 s36, s4, s6
    buffer_load_dwordx4 v[144:147], v21, s[16:19], s36 offen
    buffer_load_dwordx4 v[144:147], v21, s[16:19], s36 offen offset:1024
    s_branch .Lnowarm
.Lwarm0:
    buffer_load_dwordx4 v[144:147], v17, s[16:19], 0 offen
.Lnowarm:
    s_sleep 10
    s_movk_i32 s33, 3
    buffer_load_dwordx4 v[212:215], v6, s[16:19], s31 offen sc1
    buffer_load_dwordx4 v[216:219], v6, s[16:19], s60 offen sc1
    buffer_load_dwordx4 v[220:223], v226, s[16:19], 0 offen sc1
    v_lshrrev_b32 v189, 2, v1
    v_and_b32 v190, 7, v189
    v_and_b32 v188, 3, v1
    v_lshlrev_b32 v188, 3, v188
    v_lshl_add_u32 v188, v189, 8, v188
    v_lshl_add_u32 v188, v190, 5, v188
    s_lshl_b32 s36, s22, 13
    s_add_u32 s36, s36, 65536
    v_add_u32 v188, s36, v188
    v_xor_b32 v189, 32, v188
    v_xor_b32 v190, 64, v188
    v_xor_b32 v191, 96, v188
    v_xor_b32 v192, 128, v188
    v_xor_b32 v193, 160, v188
    v_xor_b32 v194, 192, v188
    v_xor_b32 v195, 224, v188
    v_mov_b32 v196, 0
    v_mov_b32 v197, 0
    v_mov_b32 v198, 0
    v_mov_b32 v199, 0
    v_mov_b32 v200, 0
    v_mov_b32 v201, 0
    v_mov_b32 v202, 0
    v_mov_b32 v203, 0
    v_mov_b32 v204, 0
    v_mov_b32 v205, 0
    v_mov_b32 v206, 0
    v_mov_b32 v207, 0
    v_mov_b32 v208, 0
    v_mov_b32 v209, 0
    v_mov_b32 v210, 0
    v_mov_b32 v211, 0
.kf_4:
    ds_read_b32 v228, v19 offset:2448
    s_sub_u32 s30, s30, 1
    s_cbranch_scc1 .Lfail0
    s_waitcnt lgkmcnt(0)
    v_cmp_eq_u32 vcc, 0, v228
    s_cbranch_vccnz .kf_4
    v_and_b32 v229, 15, v1
    v_lshrrev_b32 v230, 4, v1
    v_xor_b32 v230, v230, v229
    v_lshlrev_b32 v228, 8, v229
    v_lshl_add_u32 v228, v230, 4, v228
    s_lshl_b32 s36, s22, 13
    s_add_u32 s36, s36, 32768
    v_add_u32 v228, s36, v228
    v_xor_b32 v229, 64, v228
    v_xor_b32 v230, 128, v228
    v_xor_b32 v231, 192, v228
    ds_read_b128 v[56:59], v228 offset:0
    ds_read_b128 v[72:75], v228 offset:4096
    ds_read_b128 v[60:63], v229 offset:0
    ds_read_b128 v[76:79], v229 offset:4096
    ds_read_b128 v[64:67], v230 offset:0
    ds_read_b128 v[80:83], v230 offset:4096
    ds_read_b128 v[68:71], v231 offset:0
    ds_read_b128 v[84:87], v231 offset:4096
    s_branch .poll_2
.miss_3:
    s_sub_u32 s30, s30, 1
    s_cbranch_scc1 .Lfail0
    s_sub_u32 s33, s33, 1
    s_cmp_lg_u32 s33, 0
    s_cbranch_scc1 .norp_5
    buffer_store_dword v178, v4, s[16:19], s31 offen sc1
    buffer_store_dwordx4 v[184:187], v5, s[16:19], 0 offen sc1
.norp_5:
    s_mov_b64 exec, vcc
    buffer_load_dwordx4 v[212:215], v6, s[16:19], s31 offen sc1
    buffer_load_dwordx4 v[216:219], v6, s[16:19], s60 offen sc1
    buffer_load_dwordx4 v[220:223], v226, s[16:19], 0 offen sc1
    s_mov_b64 exec, -1
.poll_2:
    s_waitcnt vmcnt(0)
    v_xor_b32 v228, s64, v212
    v_xor_b32 v229, s64, v213
    v_xor_b32 v230, s64, v214
    v_xor_b32 v231, s64, v215
    v_xor_b32 v232, s64, v216
    v_xor_b32 v233, s64, v217
    v_xor_b32 v234, s64, v218
    v_xor_b32 v235, s64, v219
    v_pk_add_f32 v[236:237], v[228:229], v[232:233]
    v_pk_add_f32 v[238:239], v[230:231], v[234:235]
    v_or3_b32 v240, v228, v229, v230
    v_or3_b32 v240, v240, v231, v232
    v_permlane32_swap_b32 v236, v238
    v_permlane32_swap_b32 v237, v239
    v_add_f32 v241, v236, v238
    v_add_f32 v242, v237, v239
    v_or3_b32 v240, v240, v233, v234
    v_bitop3_b32 v240, v240, v235, v3 bitop3:0xa8
    v_bitop3_b32 v243, v222, v223, v186 bitop3:0x7e
    v_or_b32 v240, v240, v243
    v_cmp_ne_u32 s[34:35], s26, v220
    v_cmp_ne_u32 vcc, 0, v240
    v_cvt_pk_bf16_f32 v241, v241, v242
    s_cbranch_vccnz .miss_3
.qok_1:
    ds_write_b32 v8, v241 offset:1024
    s_or_b32 s36, s34, s35
    s_cselect_b32 s36, 0x10001, 1
    s_lshl_b32 s37, s22, 2
    v_mov_b32 v228, s37
    v_mov_b32 v229, s36
    ds_write_b32 v228, v229 offset:2432
    s_movk_i32 s33, 30
.fl_6:
    ds_read_b128 v[228:231], v19 offset:2432
    s_waitcnt lgkmcnt(0)
    v_add3_u32 v228, v228, v229, v230
    v_add_u32 v228, v228, v231
    s_nop 0
    v_readfirstlane_b32 s36, v228
    s_bitcmp1_b32 s36, 2
    s_cbranch_scc1 .flok_7
    s_sub_u32 s33, s33, 1
    s_cmp_lg_u32 s33, 0
    s_cbranch_scc1 .norp_8
    buffer_store_dword v178, v4, s[16:19], s31 offen sc1
    buffer_store_dwordx4 v[184:187], v5, s[16:19], 0 offen sc1
.norp_8:
    s_sub_u32 s30, s30, 1
    s_cbranch_scc0 .fl_6
    s_branch .Lfail0
.flok_7:
    s_cmp_eq_u32 s36, 4
    s_cselect_b32 s10, s18, 0
    s_cselect_b32 s14, 0, s18
    ds_read_b128 v[152:155], v9 offset:1024
    ds_read_b128 v[156:159], v9 offset:1088
    ds_read_b128 v[160:163], v9 offset:1152
    ds_read_b128 v[164:167], v9 offset:1216
    s_waitcnt lgkmcnt(3)
    v_mfma_f32_16x16x32_bf16 v[168:171], v[56:59], v[152:155], 0
    v_mfma_f32_16x16x32_bf16 v[172:175], v[72:75], v[152:155], 0
    s_waitcnt lgkmcnt(2)
    v_mfma_f32_16x16x32_bf16 v[168:171], v[60:63], v[156:159], v[168:171]
    v_mfma_f32_16x16x32_bf16 v[172:175], v[76:79], v[156:159], v[172:175]
    s_waitcnt lgkmcnt(1)
    v_mfma_f32_16x16x32_bf16 v[168:171], v[64:67], v[160:163], v[168:171]
    v_mfma_f32_16x16x32_bf16 v[172:175], v[80:83], v[160:163], v[172:175]
    s_waitcnt lgkmcnt(0)
    v_mfma_f32_16x16x32_bf16 v[168:171], v[68:71], v[164:167], v[168:171]
    v_mfma_f32_16x16x32_bf16 v[172:175], v[84:87], v[164:167], v[172:175]
    s_nop 6
    v_max3_f32 v229, v168, v169, v170
    v_max3_f32 v230, v172, v173, v174
    v_max3_f32 v229, v229, v171, v175
    v_max_f32 v229, v229, v230
    v_mov_b32 v230, v229
    s_nop 1
    v_permlane32_swap_b32 v229, v230
    v_max_f32 v229, v229, v230
    v_mov_b32 v230, v229
    s_nop 1
    v_permlane16_swap_b32 v229, v230
    v_max_f32 v229, v229, v230
    v_mul_f32 v244, s24, v229
    v_fma_f32 v168, v168, s24, -v244
    v_fma_f32 v169, v169, s24, -v244
    v_fma_f32 v170, v170, s24, -v244
    v_fma_f32 v171, v171, s24, -v244
    v_fma_f32 v172, v172, s24, -v244
    v_fma_f32 v173, v173, s24, -v244
    v_fma_f32 v174, v174, s24, -v244
    v_fma_f32 v175, v175, s24, -v244
    v_exp_f32 v168, v168
    v_exp_f32 v169, v169
    v_exp_f32 v170, v170
    v_exp_f32 v171, v171
    v_exp_f32 v172, v172
    v_exp_f32 v173, v173
    v_exp_f32 v174, v174
    v_exp_f32 v175, v175
    s_mov_b64 exec, s[48:49]
    v_cvt_pk_bf16_f32 v196, v168, v169
    v_cvt_pk_bf16_f32 v197, v170, v171
    v_cvt_pk_bf16_f32 v198, v172, v173
    v_cvt_pk_bf16_f32 v199, v174, v175
    s_mov_b64 exec, s[50:51]
    v_cvt_pk_bf16_f32 v200, v168, v169
    v_cvt_pk_bf16_f32 v201, v170, v171
    v_cvt_pk_bf16_f32 v202, v172, v173
    v_cvt_pk_bf16_f32 v203, v174, v175
    s_mov_b64 exec, s[52:53]
    v_cvt_pk_bf16_f32 v204, v168, v169
    v_cvt_pk_bf16_f32 v205, v170, v171
    v_cvt_pk_bf16_f32 v206, v172, v173
    v_cvt_pk_bf16_f32 v207, v174, v175
    s_mov_b64 exec, s[54:55]
    v_cvt_pk_bf16_f32 v208, v168, v169
    v_cvt_pk_bf16_f32 v209, v170, v171
    v_cvt_pk_bf16_f32 v210, v172, v173
    v_cvt_pk_bf16_f32 v211, v174, v175
    s_mov_b64 exec, -1
    v_pk_add_f32 v[168:169], v[168:169], v[170:171]
    v_pk_add_f32 v[172:173], v[172:173], v[174:175]
    v_pk_add_f32 v[168:169], v[168:169], v[172:173]
    v_add_f32 v245, v168, v169
    v_mov_b32 v229, v245
    s_nop 1
    v_permlane32_swap_b32 v245, v229
    v_add_f32 v245, v245, v229
    v_mov_b32 v229, v245
    s_nop 1
    v_permlane16_swap_b32 v245, v229
    v_add_f32 v245, v245, v229
    ds_write_b64 v11, v[244:245] offset:2176
    buffer_store_dword v178, v4, s[12:15], s31 offen sc1
    buffer_store_dwordx4 v[184:187], v5, s[12:15], 0 offen sc1
    buffer_store_dword v179, v4, s[8:11], s29 offen
    buffer_store_dword v179, v4, s[12:15], s29 offen sc1
    v_and_b32 v35, 0xffff0000, v34
    v_lshlrev_b32 v34, 16, v34
    s_waitcnt lgkmcnt(0)
    s_barrier
    ds_read_b64_tr_b16 v[88:89], v188 offset:0
    ds_read_b64_tr_b16 v[90:91], v188 offset:4096
    ds_read_b64_tr_b16 v[104:105], v192 offset:0
    ds_read_b64_tr_b16 v[106:107], v192 offset:4096
    ds_read_b64_tr_b16 v[92:93], v189 offset:0
    ds_read_b64_tr_b16 v[94:95], v189 offset:4096
    ds_read_b64_tr_b16 v[108:109], v193 offset:0
    ds_read_b64_tr_b16 v[110:111], v193 offset:4096
    ds_read_b64_tr_b16 v[96:97], v190 offset:0
    ds_read_b64_tr_b16 v[98:99], v190 offset:4096
    ds_read_b64_tr_b16 v[112:113], v194 offset:0
    ds_read_b64_tr_b16 v[114:115], v194 offset:4096
    ds_read_b64_tr_b16 v[100:101], v191 offset:0
    ds_read_b64_tr_b16 v[102:103], v191 offset:4096
    ds_read_b64_tr_b16 v[116:117], v195 offset:0
    ds_read_b64_tr_b16 v[118:119], v195 offset:4096
    s_waitcnt lgkmcnt(12)
    v_mfma_f32_16x16x32_bf16 v[188:191], v[88:91], v[196:199], 0
    v_mfma_f32_16x16x32_bf16 v[192:195], v[104:107], v[196:199], 0
    s_waitcnt lgkmcnt(8)
    v_mfma_f32_16x16x32_bf16 v[188:191], v[92:95], v[200:203], v[188:191]
    v_mfma_f32_16x16x32_bf16 v[192:195], v[108:111], v[200:203], v[192:195]
    s_waitcnt lgkmcnt(4)
    v_mfma_f32_16x16x32_bf16 v[188:191], v[96:99], v[204:207], v[188:191]
    v_mfma_f32_16x16x32_bf16 v[192:195], v[112:115], v[204:207], v[192:195]
    s_waitcnt lgkmcnt(0)
    v_mfma_f32_16x16x32_bf16 v[188:191], v[100:103], v[208:211], v[188:191]
    v_mfma_f32_16x16x32_bf16 v[192:195], v[116:119], v[208:211], v[192:195]
    s_nop 6
    ds_write_b128 v10, v[188:191] offset:4608
    ds_write_b128 v10, v[192:195] offset:4864
    s_add_u32 s36, s27, 2
    v_mov_b32 v250, s36
    v_mov_b32 v251, s36
    s_waitcnt lgkmcnt(0)
    s_barrier
    ds_read_b64 v[228:229], v13 offset:2176
    ds_read_b64 v[232:233], v12 offset:4608
    ds_read_b64 v[234:235], v12 offset:6720
    ds_read_b64 v[236:237], v12 offset:8832
    ds_read_b64 v[238:239], v12 offset:10944
    s_waitcnt lgkmcnt(4)
    v_max_f32_dpp v248, v228, v228 quad_perm:[1,0,3,2] row_mask:0xf bank_mask:0xf
    s_nop 1
    v_max_f32_dpp v248, v248, v248 quad_perm:[2,3,0,1] row_mask:0xf bank_mask:0xf
    v_sub_f32 v240, v228, v248
    v_exp_f32 v240, v240
    s_waitcnt lgkmcnt(0)
    v_mul_f32 v249, v240, v229
    v_mul_f32_dpp v242, v240, v232 quad_perm:[0,0,0,0] row_mask:0xf bank_mask:0xf
    v_mul_f32_dpp v243, v240, v233 quad_perm:[0,0,0,0] row_mask:0xf bank_mask:0xf
    v_add_f32_dpp v249, v249, v249 quad_perm:[1,0,3,2] row_mask:0xf bank_mask:0xf
    v_fmac_f32_dpp v242, v240, v234 quad_perm:[1,1,1,1] row_mask:0xf bank_mask:0xf
    v_fmac_f32_dpp v243, v240, v235 quad_perm:[1,1,1,1] row_mask:0xf bank_mask:0xf
    v_add_f32_dpp v249, v249, v249 quad_perm:[2,3,0,1] row_mask:0xf bank_mask:0xf
    v_fmac_f32_dpp v242, v240, v236 quad_perm:[2,2,2,2] row_mask:0xf bank_mask:0xf
    v_fmac_f32_dpp v243, v240, v237 quad_perm:[2,2,2,2] row_mask:0xf bank_mask:0xf
    s_nop 0
    v_fmac_f32_dpp v242, v240, v238 quad_perm:[3,3,3,3] row_mask:0xf bank_mask:0xf
    v_fmac_f32_dpp v243, v240, v239 quad_perm:[3,3,3,3] row_mask:0xf bank_mask:0xf
    v_bfi_b32 v242, v2, v242, s65
    v_bfi_b32 v243, v2, v243, s65
    buffer_store_dwordx2 v[242:243], v14, s[8:11], 0 offen
    buffer_store_dwordx4 v[248:251], v15, s[8:11], 0 offen
    buffer_store_dwordx2 v[242:243], v14, s[12:15], 0 offen sc1
    buffer_store_dwordx4 v[248:251], v15, s[12:15], 0 offen sc1
    s_cmp_lt_u32 s21, 14
    s_cbranch_scc1 .F_9
    s_sleep 3
    buffer_load_dwordx4 v[212:215], v16, s[16:19], 0 offen sc1
    buffer_load_dwordx4 v[216:219], v17, s[16:19], 0 offen sc1
    s_barrier
    s_waitcnt vmcnt(6)
    v_lshrrev_b32 v239, 4, v1
    v_bfe_u32 v240, v1, 2, 2
    v_lshl_add_u32 v238, v239, 3, v240
    v_lshlrev_b32 v238, 10, v238
    v_bfe_u32 v239, v1, 2, 3
    v_lshl_add_u32 v238, v239, 5, v238
    v_and_b32 v239, 3, v1
    v_lshl_add_u32 v238, v239, 3, v238
    s_lshl_b32 s36, s22, 8
    s_add_u32 s36, s36, 98304
    v_add_u32 v238, s36, v238
    v_xor_b32 v239, 32, v238
    v_xor_b32 v240, 64, v238
    v_xor_b32 v241, 96, v238
    v_xor_b32 v242, 128, v238
    v_xor_b32 v243, 160, v238
    v_xor_b32 v244, 192, v238
    v_xor_b32 v245, 224, v238
    ds_read_b64_tr_b16 v[120:121], v238 offset:0
    ds_read_b64_tr_b16 v[122:123], v238 offset:4096
    ds_read_b64_tr_b16 v[124:125], v239 offset:0
    ds_read_b64_tr_b16 v[126:127], v239 offset:4096
    ds_read_b64_tr_b16 v[128:129], v240 offset:0
    ds_read_b64_tr_b16 v[130:131], v240 offset:4096
    ds_read_b64_tr_b16 v[132:133], v241 offset:0
    ds_read_b64_tr_b16 v[134:135], v241 offset:4096
    ds_read_b64_tr_b16 v[136:137], v242 offset:0
    ds_read_b64_tr_b16 v[138:139], v242 offset:4096
    ds_read_b64_tr_b16 v[140:141], v243 offset:0
    ds_read_b64_tr_b16 v[142:143], v243 offset:4096
    ds_read_b64_tr_b16 v[144:145], v244 offset:0
    ds_read_b64_tr_b16 v[146:147], v244 offset:4096
    ds_read_b64_tr_b16 v[148:149], v245 offset:0
    ds_read_b64_tr_b16 v[150:151], v245 offset:4096
    s_branch .poll_11
.miss_12:
    s_sub_u32 s30, s30, 1
    s_cbranch_scc1 .Lfail1
    s_mov_b64 exec, vcc
    buffer_load_dwordx4 v[212:215], v16, s[16:19], 0 offen sc1
    buffer_load_dwordx4 v[216:219], v17, s[16:19], 0 offen sc1
    s_mov_b64 exec, -1
.poll_11:
    s_waitcnt vmcnt(0)
    v_max_f32_dpp v232, v216, v216 row_ror:1 row_mask:0xf bank_mask:0xf
    v_xor_b32 v228, s65, v212
    v_xor_b32 v229, s65, v213
    v_max_f32_dpp v232, v232, v232 row_ror:2 row_mask:0xf bank_mask:0xf
    v_xor_b32 v230, s65, v214
    v_xor_b32 v231, s65, v215
    v_max_f32_dpp v232, v232, v232 row_ror:4 row_mask:0xf bank_mask:0xf
    v_or3_b32 v236, v228, v229, v230
    v_bitop3_b32 v236, v236, v231, v3 bitop3:0xa8
    v_max_f32_dpp v232, v232, v232 row_ror:8 row_mask:0xf bank_mask:0xf
    v_bitop3_b32 v237, v218, v219, v250 bitop3:0x7e
    v_mov_b32 v233, v232
    v_or_b32 v236, v236, v237
    v_cmp_ne_u32 vcc, 0, v236
    v_permlane16_swap_b32 v232, v233
    v_max_f32 v232, v232, v233
    v_sub_f32 v232, v216, v232
    v_exp_f32 v232, v232
    s_cbranch_vccnz .miss_12
    v_mul_f32 v234, v232, v217
    v_mul_f32 v228, v232, v228
    v_mul_f32 v229, v232, v229
    v_mul_f32 v230, v232, v230
    v_mul_f32 v231, v232, v231
    v_add_f32_dpp v234, v234, v234 row_ror:1 row_mask:0xf bank_mask:0xf
    v_permlane16_swap_b32 v228, v229
    v_permlane16_swap_b32 v230, v231
    v_add_f32_dpp v234, v234, v234 row_ror:2 row_mask:0xf bank_mask:0xf
    v_add_f32 v228, v228, v229
    v_add_f32 v230, v230, v231
    v_add_f32_dpp v234, v234, v234 row_ror:4 row_mask:0xf bank_mask:0xf
    v_add_f32_dpp v232, v228, v228 row_ror:8 row_mask:0xf bank_mask:0x3
    s_nop 1
    v_add_f32_dpp v232, v230, v230 row_ror:8 row_mask:0xf bank_mask:0xc
    v_add_f32_dpp v234, v234, v234 row_ror:8 row_mask:0xf bank_mask:0xf
    s_nop 0
    v_add_f32_dpp v232, v232, v232 row_half_mirror row_mask:0xf bank_mask:0xf
    v_mov_b32 v233, v234
    s_nop 0
    v_add_f32_dpp v232, v232, v232 quad_perm:[1,0,3,2] row_mask:0xf bank_mask:0xf
    v_permlane16_swap_b32 v234, v233
    v_add_f32 v234, v234, v233
    v_add_f32_dpp v232, v232, v232 quad_perm:[2,3,0,1] row_mask:0xf bank_mask:0xf
    v_rcp_f32 v234, v234
    s_nop 0
    v_mul_f32 v232, v232, v234
    v_cvt_pk_bf16_f32 v232, v232, v232
    ds_write_b16 v18, v232 offset:2304
    s_waitcnt lgkmcnt(0)
    s_barrier
    s_mov_b64 exec, s[48:49]
    ds_read_b128 v[196:199], v28 offset:2304
    s_mov_b64 exec, s[50:51]
    ds_read_b128 v[200:203], v28 offset:2304
    s_mov_b64 exec, s[52:53]
    ds_read_b128 v[204:207], v28 offset:2304
    s_mov_b64 exec, s[54:55]
    ds_read_b128 v[208:211], v28 offset:2304
    s_mov_b64 exec, -1
    s_waitcnt lgkmcnt(3)
    v_mfma_f32_16x16x32_bf16 v[168:171], v[196:199], v[120:123], 0
    v_mfma_f32_16x16x32_bf16 v[172:175], v[196:199], v[136:139], 0
    s_waitcnt lgkmcnt(2)
    v_mfma_f32_16x16x32_bf16 v[168:171], v[200:203], v[124:127], v[168:171]
    v_mfma_f32_16x16x32_bf16 v[172:175], v[200:203], v[140:143], v[172:175]
    s_waitcnt lgkmcnt(1)
    v_mfma_f32_16x16x32_bf16 v[168:171], v[204:207], v[128:131], v[168:171]
    v_mfma_f32_16x16x32_bf16 v[172:175], v[204:207], v[144:147], v[172:175]
    s_waitcnt lgkmcnt(0)
    v_mfma_f32_16x16x32_bf16 v[168:171], v[208:211], v[132:135], v[168:171]
    v_mfma_f32_16x16x32_bf16 v[172:175], v[208:211], v[148:151], v[172:175]
    s_nop 6
    v_bfi_b32 v168, v2, v168, s66
    v_bfi_b32 v172, v2, v172, s66
    buffer_store_dword v168, v20, s[8:11], s4 offen
    buffer_store_dword v172, v20, s[8:11], s5 offen
    buffer_store_dword v168, v20, s[12:15], s4 offen sc1
    buffer_store_dword v172, v20, s[12:15], s5 offen sc1
    s_cmp_lg_u32 s22, 0
    s_cbranch_scc1 .nw_13
    s_sleep 4
    buffer_load_dwordx4 v[212:215], v21, s[16:19], s4 offen sc1
    buffer_load_dwordx4 v[216:219], v21, s[16:19], s4 offen offset:1024 sc1
    s_branch .poll_16
.miss_17:
    s_sub_u32 s30, s30, 1
    s_cbranch_scc1 .Lfail2
    s_mov_b64 exec, vcc
    buffer_load_dwordx4 v[212:215], v21, s[16:19], s4 offen sc1
    buffer_load_dwordx4 v[216:219], v21, s[16:19], s4 offen offset:1024 sc1
    s_mov_b64 exec, -1
.poll_16:
    s_waitcnt vmcnt(0)
    v_xor_b32 v228, s66, v212
    v_xor_b32 v229, s66, v213
    v_xor_b32 v230, s66, v214
    v_xor_b32 v231, s66, v215
    v_xor_b32 v232, s66, v216
    v_xor_b32 v233, s66, v217
    v_xor_b32 v234, s66, v218
    v_xor_b32 v235, s66, v219
    v_pk_add_f32 v[236:237], v[228:229], v[232:233]
    v_pk_add_f32 v[238:239], v[230:231], v[234:235]
    v_or3_b32 v240, v228, v229, v230
    v_or3_b32 v240, v240, v231, v232
    v_permlane32_swap_b32 v236, v237
    v_permlane32_swap_b32 v238, v239
    v_add_f32 v236, v236, v237
    v_add_f32 v238, v238, v239
    v_or3_b32 v240, v240, v233, v234
    v_bitop3_b32 v240, v240, v235, v3 bitop3:0xa8
    v_permlane16_swap_b32 v236, v238
    v_add_f32 v236, v236, v238
    v_cmp_ne_u32 vcc, 0, v240
    s_nop 0
    v_add_f32_dpp v236, v236, v236 row_ror:8 row_mask:0xf bank_mask:0xf
    v_bfi_b32 v236, v2, v236, s67
    s_cbranch_vccnz .miss_17
    buffer_store_dword v236, v24, s[16:19], s56 offen sc1
.nw_13:
    buffer_load_dwordx4 v[212:215], v6, s[16:19], s29 offen sc1
    buffer_load_dwordx4 v[216:219], v6, s[16:19], s61 offen sc1
    s_branch .poll_18
.miss_19:
    s_sub_u32 s30, s30, 1
    s_cbranch_scc1 .Lfail12
    s_mov_b64 exec, vcc
    buffer_load_dwordx4 v[212:215], v6, s[16:19], s29 offen sc1
    buffer_load_dwordx4 v[216:219], v6, s[16:19], s61 offen sc1
    s_mov_b64 exec, -1
.poll_18:
    s_waitcnt vmcnt(0)
    v_xor_b32 v228, s76, v212
    v_xor_b32 v229, s76, v213
    v_xor_b32 v230, s76, v214
    v_xor_b32 v231, s76, v215
    v_xor_b32 v232, s76, v216
    v_xor_b32 v233, s76, v217
    v_xor_b32 v234, s76, v218
    v_xor_b32 v235, s76, v219
    v_pk_add_f32 v[236:237], v[228:229], v[232:233]
    v_pk_add_f32 v[238:239], v[230:231], v[234:235]
    v_or3_b32 v240, v228, v229, v230
    v_or3_b32 v240, v240, v231, v232
    v_permlane32_swap_b32 v236, v238
    v_permlane32_swap_b32 v237, v239
    v_add_f32 v36, v236, v238
    v_add_f32 v37, v237, v239
    v_or3_b32 v240, v240, v233, v234
    v_bitop3_b32 v240, v240, v235, v3 bitop3:0xa8
    v_cmp_ne_u32 vcc, 0, v240
    s_cbranch_vccnz .miss_19
    s_cmp_lg_u32 s22, 0
    s_cbranch_scc1 .nw_14
    s_sleep 32
    v_and_b32 v242, s68, v23
    buffer_load_dwordx4 v[212:215], v21, s[16:19], s6 offen sc1
    buffer_load_dwordx4 v[216:219], v22, s[16:19], s6 offen offset:1024 sc1
    s_branch .poll_20
.miss_21:
    s_sub_u32 s30, s30, 1
    s_cbranch_scc1 .Lfail4
    s_mov_b64 exec, vcc
    buffer_load_dwordx4 v[212:215], v21, s[16:19], s6 offen sc1
    buffer_load_dwordx4 v[216:219], v22, s[16:19], s6 offen offset:1024 sc1
    s_mov_b64 exec, -1
.poll_20:
    s_waitcnt vmcnt(0)
    v_xor_b32 v228, s68, v212
    v_xor_b32 v229, s68, v213
    v_xor_b32 v230, s68, v214
    v_xor_b32 v231, s68, v215
    v_xor_b32 v232, v242, v216
    v_xor_b32 v233, v242, v217
    v_xor_b32 v234, v242, v218
    v_xor_b32 v235, v242, v219
    v_pk_add_f32 v[236:237], v[228:229], v[232:233]
    v_pk_add_f32 v[238:239], v[230:231], v[234:235]
    v_or3_b32 v240, v228, v229, v230
    v_or3_b32 v240, v240, v231, v232
    v_permlane32_swap_b32 v236, v237
    v_permlane32_swap_b32 v238, v239
    v_add_f32 v236, v236, v237
    v_add_f32 v238, v238, v239
    v_or3_b32 v240, v240, v233, v234
    v_bitop3_b32 v240, v240, v235, v3 bitop3:0xa8
    v_permlane16_swap_b32 v236, v238
    v_add_f32 v236, v236, v238
    v_cmp_ne_u32 vcc, 0, v240
    s_nop 0
    v_add_f32_dpp v236, v236, v236 row_ror:8 row_mask:0xf bank_mask:0xf
    v_bfi_b32 v236, v2, v236, s69
    s_cbranch_vccnz .miss_21
    buffer_store_dword v236, v24, s[16:19], s57 offen sc1
.nw_14:
    s_barrier
    s_sleep 14
    s_branch .join_10
.F_9:
    s_barrier
    s_waitcnt vmcnt(0)
    v_lshrrev_b32 v228, 4, v1
    v_and_b32 v229, 15, v1
    v_lshlrev_b32 v229, 3, v229
    v_lshl_add_u32 v228, v228, 8, v229
    s_lshl_b32 s36, s22, 12
    s_add_u32 s36, s36, 98304
    v_add_u32 v228, s36, v228
    ds_read_b64_tr_b16 v[120:121], v228 offset:0
    ds_read_b64_tr_b16 v[122:123], v228 offset:128
    ds_read_b64_tr_b16 v[124:125], v228 offset:1024
    ds_read_b64_tr_b16 v[126:127], v228 offset:1152
    ds_read_b64_tr_b16 v[128:129], v228 offset:2048
    ds_read_b64_tr_b16 v[130:131], v228 offset:2176
    ds_read_b64_tr_b16 v[132:133], v228 offset:3072
    ds_read_b64_tr_b16 v[134:135], v228 offset:3200
    v_bfe_u32 v231, v1, 2, 2
    v_lshrrev_b32 v232, 4, v1
    v_xor_b32 v232, v232, v231
    v_and_b32 v230, 3, v1
    v_lshlrev_b32 v230, 3, v230
    v_lshl_add_u32 v230, v231, 10, v230
    v_lshl_add_u32 v230, v232, 5, v230
    s_lshl_b32 s36, s22, 8
    s_add_u32 s36, s36, 114688
    v_add_u32 v230, s36, v230
    v_xor_b32 v231, 128, v230
    ds_read_b64_tr_b16 v[136:137], v230 offset:0
    ds_read_b64_tr_b16 v[144:145], v231 offset:0
    ds_read_b64_tr_b16 v[138:139], v230 offset:4096
    ds_read_b64_tr_b16 v[146:147], v231 offset:4096
    ds_read_b64_tr_b16 v[140:141], v231 offset:8192
    ds_read_b64_tr_b16 v[148:149], v230 offset:8192
    ds_read_b64_tr_b16 v[142:143], v231 offset:12288
    ds_read_b64_tr_b16 v[150:151], v230 offset:12288
    v_mov_b32 v180, s25
    v_mov_b32 v181, s25
    v_mov_b32 v182, s25
    v_mov_b32 v183, s25
    s_waitcnt lgkmcnt(0)
    s_nop 0
    v_mfma_f32_16x16x32_bf16 v[168:171], v[180:183], v[120:123], 0
    v_mfma_f32_16x16x32_bf16 v[168:171], v[180:183], v[124:127], v[168:171]
    v_mfma_f32_16x16x32_bf16 v[168:171], v[180:183], v[128:131], v[168:171]
    v_mfma_f32_16x16x32_bf16 v[168:171], v[180:183], v[132:135], v[168:171]
    s_nop 7
    ds_write_b32 v30, v168 offset:2560
    s_waitcnt lgkmcnt(0)
    s_barrier
    ds_read_b128 v[228:231], v31 offset:2560
    s_waitcnt lgkmcnt(0)
    v_pk_add_f32 v[228:229], v[228:229], v[230:231]
    v_add_f32 v38, v228, v229
    buffer_load_dwordx4 v[212:215], v6, s[16:19], s29 offen sc1
    buffer_load_dwordx4 v[216:219], v6, s[16:19], s61 offen sc1
    s_branch .poll_22
.miss_23:
    s_sub_u32 s30, s30, 1
    s_cbranch_scc1 .Lfail12
    s_mov_b64 exec, vcc
    buffer_load_dwordx4 v[212:215], v6, s[16:19], s29 offen sc1
    buffer_load_dwordx4 v[216:219], v6, s[16:19], s61 offen sc1
    s_mov_b64 exec, -1
.poll_22:
    s_waitcnt vmcnt(0)
    v_xor_b32 v228, s76, v212
    v_xor_b32 v229, s76, v213
    v_xor_b32 v230, s76, v214
    v_xor_b32 v231, s76, v215
    v_xor_b32 v232, s76, v216
    v_xor_b32 v233, s76, v217
    v_xor_b32 v234, s76, v218
    v_xor_b32 v235, s76, v219
    v_pk_add_f32 v[236:237], v[228:229], v[232:233]
    v_pk_add_f32 v[238:239], v[230:231], v[234:235]
    v_or3_b32 v240, v228, v229, v230
    v_or3_b32 v240, v240, v231, v232
    v_permlane32_swap_b32 v236, v238
    v_permlane32_swap_b32 v237, v239
    v_add_f32 v36, v236, v238
    v_add_f32 v37, v237, v239
    v_or3_b32 v240, v240, v233, v234
    v_bitop3_b32 v240, v240, v235, v3 bitop3:0xa8
    v_cmp_ne_u32 vcc, 0, v240
    s_cbranch_vccnz .miss_23
    s_cmp_lg_u32 s22, 0
    s_cbranch_scc1 .nw_24
    buffer_load_dwordx4 v[212:215], v21, s[16:19], s4 offen sc1
    buffer_load_dwordx4 v[216:219], v21, s[16:19], s4 offen offset:1024 sc1
    s_branch .poll_25
.miss_26:
    s_sub_u32 s30, s30, 1
    s_cbranch_scc1 .Lfail2
    s_mov_b64 exec, vcc
    buffer_load_dwordx4 v[212:215], v21, s[16:19], s4 offen sc1
    buffer_load_dwordx4 v[216:219], v21, s[16:19], s4 offen offset:1024 sc1
    s_mov_b64 exec, -1
.poll_25:
    s_waitcnt vmcnt(0)
    v_xor_b32 v228, s66, v212
    v_xor_b32 v229, s66, v213
    v_xor_b32 v230, s66, v214
    v_xor_b32 v231, s66, v215
    v_xor_b32 v232, s66, v216
    v_xor_b32 v233, s66, v217
    v_xor_b32 v234, s66, v218
    v_xor_b32 v235, s66, v219
    v_or3_b32 v240, v228, v229, v230
    v_or3_b32 v240, v240, v231, v232
    v_or3_b32 v240, v240, v233, v234
    v_bitop3_b32 v240, v240, v235, v3 bitop3:0xa8
    v_cmp_ne_u32 vcc, 0, v240
    s_cbranch_vccnz .miss_26
.nw_24:
    s_barrier
    s_sleep 16
    buffer_load_dwordx4 v[212:215], v26, s[16:19], s56 offen offset:0 sc1
    buffer_load_dwordx4 v[216:219], v26, s[16:19], s56 offen offset:512 sc1
    buffer_load_dwordx4 v[220:223], v26, s[16:19], s56 offen offset:1024 sc1
    buffer_load_dwordx4 v[224:227], v26, s[16:19], s56 offen offset:1536 sc1
    s_branch .poll_27
.miss_28:
    s_sub_u32 s30, s30, 1
    s_cbranch_scc1 .Lfail3
    s_mov_b64 exec, vcc
    buffer_load_dwordx4 v[212:215], v26, s[16:19], s56 offen offset:0 sc1
    buffer_load_dwordx4 v[216:219], v26, s[16:19], s56 offen offset:512 sc1
    buffer_load_dwordx4 v[220:223], v26, s[16:19], s56 offen offset:1024 sc1
    buffer_load_dwordx4 v[224:227], v26, s[16:19], s56 offen offset:1536 sc1
    s_mov_b64 exec, -1
.poll_27:
    s_waitcnt vmcnt(0)
    v_xor_b32 v228, s67, v212
    v_xor_b32 v229, s67, v213
    v_xor_b32 v230, s67, v214
    v_xor_b32 v231, s67, v215
    v_xor_b32 v232, s67, v216
    v_xor_b32 v233, s67, v217
    v_xor_b32 v234, s67, v218
    v_xor_b32 v235, s67, v219
    v_xor_b32 v236, s67, v220
    v_xor_b32 v237, s67, v221
    v_xor_b32 v238, s67, v222
    v_xor_b32 v239, s67, v223
    v_xor_b32 v240, s67, v224
    v_xor_b32 v241, s67, v225
    v_xor_b32 v242, s67, v226
    v_xor_b32 v243, s67, v227
    v_pk_add_f32 v[244:245], v[228:229], v[232:233]
    v_pk_add_f32 v[246:247], v[230:231], v[234:235]
    v_pk_add_f32 v[250:251], v[236:237], v[240:241]
    v_pk_add_f32 v[252:253], v[238:239], v[242:243]
    v_pk_add_f32 v[244:245], v[244:245], v[250:251]
    v_pk_add_f32 v[246:247], v[246:247], v[252:253]
    v_or3_b32 v248, v228, v229, v230
    v_or3_b32 v248, v248, v231, v232
    v_permlane32_swap_b32 v244, v246
    v_permlane32_swap_b32 v245, v247
    v_pk_add_f32 v[244:245], v[244:245], v[246:247]
    v_or3_b32 v248, v248, v233, v234
    v_cvt_pk_bf16_f32 v244, v244, v245
    v_or3_b32 v248, v248, v235, v236
    v_and_b32 v245, 0xffff0000, v244
    v_lshlrev_b32 v244, 16, v244
    v_or3_b32 v248, v248, v237, v238
    v_add_f32 v244, v34, v244
    v_add_f32 v245, v35, v245
    v_or3_b32 v248, v248, v239, v240
    v_or3_b32 v248, v248, v241, v242
    v_bitop3_b32 v248, v248, v243, v3 bitop3:0xa8
    v_cmp_ne_u32 vcc, 0, v248
    v_cvt_pk_bf16_f32 v228, v244, v245
    s_cbranch_vccnz .miss_28
    ds_write_b32 v29, v228 offset:0
    v_lshlrev_b32 v34, 16, v228
    v_and_b32 v35, 0xffff0000, v228
    s_lshl_b32 s36, s22, 8
    v_add_u32 v229, s36, v28
    v_add_f32 v230, v34, v35
    v_mul_f32 v231, v34, v34
    v_fmac_f32 v231, v35, v35
    ds_read_b128 v[152:155], v229 offset:0
    ds_read_b128 v[156:159], v229 offset:64
    ds_read_b128 v[160:163], v229 offset:128
    ds_read_b128 v[164:167], v229 offset:192
    v_permlane32_swap_b32 v230, v231
    v_add_f32 v230, v230, v231
    v_mov_b32 v231, v230
    s_nop 1
    v_permlane16_swap_b32 v230, v231
    v_add_f32 v230, v230, v231
    v_or_b32 v232, s67, v34
    s_nop 0
    v_add_f32_dpp v230, v230, v230 row_ror:8 row_mask:0xf bank_mask:0xf
    v_or_b32 v233, s67, v35
    s_nop 0
    v_add_f32_dpp v230, v230, v230 row_ror:4 row_mask:0xf bank_mask:0xf
    v_lshl_add_u32 v234, v29, 1, s79
    s_nop 0
    v_add_f32_dpp v230, v230, v230 row_ror:2 row_mask:0xf bank_mask:0xf
    s_nop 0
    s_nop 0
    v_add_f32_dpp v230, v230, v230 row_ror:1 row_mask:0xf bank_mask:0xf
    s_waitcnt lgkmcnt(3)
    v_mfma_f32_16x16x32_bf16 v[168:171], v[152:155], v[120:123], 0
    s_waitcnt lgkmcnt(2)
    v_mfma_f32_16x16x32_bf16 v[168:171], v[156:159], v[124:127], v[168:171]
    s_waitcnt lgkmcnt(1)
    v_mfma_f32_16x16x32_bf16 v[168:171], v[160:163], v[128:131], v[168:171]
    s_waitcnt lgkmcnt(0)
    v_mfma_f32_16x16x32_bf16 v[168:171], v[164:167], v[132:135], v[168:171]
    buffer_store_dwordx2 v[232:233], v234, s[8:11], s78 offen
    buffer_store_dwordx2 v[232:233], v234, s[12:15], s78 offen sc1
    ds_write_b32 v32, v230 offset:2816
    s_nop 4
    ds_write_b32 v30, v168 offset:2560
    s_waitcnt lgkmcnt(0)
    s_barrier
    ds_read_b128 v[232:235], v19 offset:2816
    ds_read_b128 v[236:239], v19 offset:2832
    ds_read_b128 v[228:231], v31 offset:2560
    s_waitcnt lgkmcnt(1)
    v_pk_add_f32 v[232:233], v[232:233], v[234:235]
    v_pk_add_f32 v[236:237], v[236:237], v[238:239]
    v_add_f32 v232, v232, v233
    v_add_f32 v236, v236, v237
    v_mul_f32 v232, 0x3b000000, v232
    v_mul_f32 v236, 0x3b000000, v236
    v_fma_f32 v236, -v232, v232, v236
    v_max_f32 v236, 0, v236
    v_add_f32 v236, 0x3727c5ac, v236
    v_rsq_f32 v236, v236
    s_waitcnt lgkmcnt(0)
    v_pk_add_f32 v[228:229], v[228:229], v[230:231]
    v_add_f32 v228, v228, v229
    v_fma_f32 v228, -v232, v38, v228
    v_mul_f32 v228, v236, v228
    v_cvt_pk_bf16_f32 v228, 0, v228
    v_mul_f32 v229, 0xbfb8aa3b, v228
    v_exp_f32 v229, v229
    s_nop 0
    v_add_f32 v229, 1.0, v229
    v_rcp_f32 v229, v229
    s_nop 0
    v_mul_f32 v228, v228, v229
    s_nop 1
    v_mov_b32_dpp v229, v228 quad_perm:[1,0,3,2] row_mask:0xf bank_mask:0xf
    v_cvt_pk_bf16_f32 v228, v228, v229
    s_nop 0
    v_readlane_b32 s40, v228, 0
    v_readlane_b32 s41, v228, 2
    v_readlane_b32 s42, v228, 4
    v_readlane_b32 s43, v228, 6
    v_readlane_b32 s44, v228, 8
    v_readlane_b32 s45, v228, 10
    v_readlane_b32 s46, v228, 12
    v_readlane_b32 s47, v228, 14
    v_dot2_f32_bf16 v244, v136, s40, 0
    v_dot2_f32_bf16 v245, v144, s40, 0
    v_dot2_f32_bf16 v244, v137, s41, v244
    v_dot2_f32_bf16 v245, v145, s41, v245
    v_dot2_f32_bf16 v244, v138, s42, v244
    v_dot2_f32_bf16 v245, v146, s42, v245
    v_dot2_f32_bf16 v244, v139, s43, v244
    v_dot2_f32_bf16 v245, v147, s43, v245
    v_dot2_f32_bf16 v244, v140, s44, v244
    v_dot2_f32_bf16 v245, v148, s44, v245
    v_dot2_f32_bf16 v244, v141, s45, v244
    v_dot2_f32_bf16 v245, v149, s45, v245
    v_dot2_f32_bf16 v244, v142, s46, v244
    v_dot2_f32_bf16 v245, v150, s46, v245
    v_dot2_f32_bf16 v244, v143, s47, v244
    v_dot2_f32_bf16 v245, v151, s47, v245
    s_nop 1
    v_bfi_b32 v244, v2, v244, s68
    v_bfi_b32 v245, v2, v245, s68
    buffer_store_dword v244, v20, s[8:11], s6 offen
    buffer_store_dword v245, v20, s[8:11], s7 offen
    buffer_store_dword v244, v20, s[12:15], s6 offen sc1
    buffer_store_dword v245, v20, s[12:15], s7 offen sc1
    s_sleep 26
.join_10:
    buffer_load_dwordx4 v[212:215], v25, s[16:19], s57 offen sc1
    buffer_load_dword v216, v33, s[16:19], s78 offen sc1
    s_branch .poll_29
.miss_30:
    s_sub_u32 s30, s30, 1
    s_cbranch_scc1 .Lfail5
    s_mov_b64 exec, vcc
    buffer_load_dwordx4 v[212:215], v25, s[16:19], s57 offen sc1
    buffer_load_dword v216, v33, s[16:19], s78 offen sc1
    s_mov_b64 exec, -1
.poll_29:
    s_waitcnt vmcnt(0)
    v_xor_b32 v228, s69, v212
    v_xor_b32 v229, s69, v213
    v_xor_b32 v230, s69, v214
    v_xor_b32 v231, s69, v215
    v_xor_b32 v233, s67, v216
    v_or3_b32 v232, v228, v229, v230
    v_bitop3_b32 v232, v232, v231, v3 bitop3:0xa8
    v_permlane32_swap_b32 v228, v229
    v_permlane32_swap_b32 v230, v231
    v_add_f32 v228, v228, v229
    v_add_f32 v230, v230, v231
    v_lshl_or_b32 v232, v233, 16, v232
    v_cmp_ne_u32 vcc, 0, v232
    v_permlane16_swap_b32 v228, v230
    v_add_f32 v228, v228, v230
    s_nop 1
    v_add_f32_dpp v228, v228, v228 row_ror:8 row_mask:0xf bank_mask:0xf
    v_cvt_pk_bf16_f32 v228, 0, v228
    v_add_f32 v228, v233, v228
    s_cbranch_vccnz .miss_30
    v_cvt_pk_bf16_f32 v33, 0, v228
    ds_write_b16_d16_hi v27, v33 offset:3072
    v_mul_f32 v185, v33, v33
    v_mov_b32 v184, v33
    s_add_u32 s36, s27, 7
    v_mov_b32 v186, s36
    v_mov_b32 v187, s36
    v_permlane32_swap_b32 v184, v185
    v_add_f32 v184, v184, v185
    v_mov_b32 v185, v184
    s_waitcnt lgkmcnt(0)
    s_barrier
    ds_read_b128 v[152:155], v28 offset:3072
    ds_read_b128 v[156:159], v28 offset:3136
    ds_read_b128 v[160:163], v28 offset:3200
    ds_read_b128 v[164:167], v28 offset:3264
    v_lshlrev_b32 v33, 1, v255
    v_permlane16_swap_b32 v184, v185
    v_add_f32 v184, v184, v185
    s_nop 1
    v_add_f32_dpp v184, v184, v184 row_half_mirror row_mask:0xf bank_mask:0xf
    s_nop 1
    v_add_f32_dpp v184, v184, v184 quad_perm:[1,0,3,2] row_mask:0xf bank_mask:0xf
    s_nop 1
    v_add_f32_dpp v184, v184, v184 quad_perm:[2,3,0,1] row_mask:0xf bank_mask:0xf
    v_mov_b32 v185, v184
    s_nop 1
    v_permlane32_swap_b32 v184, v185
    s_waitcnt lgkmcnt(3)
    v_mfma_f32_16x16x32_bf16 v[168:171], v[152:155], v[40:43], 0
    s_waitcnt lgkmcnt(2)
    v_mfma_f32_16x16x32_bf16 v[168:171], v[156:159], v[44:47], v[168:171]
    s_waitcnt lgkmcnt(1)
    v_mfma_f32_16x16x32_bf16 v[168:171], v[160:163], v[48:51], v[168:171]
    s_waitcnt lgkmcnt(0)
    v_mfma_f32_16x16x32_bf16 v[168:171], v[164:167], v[52:55], v[168:171]
    buffer_store_dwordx4 v[184:187], v5, s[8:11], 0 offen
    buffer_store_dwordx4 v[184:187], v5, s[12:15], 0 offen sc1
    s_nop 5
    v_bfi_b32 v168, v2, v168, s70
    buffer_store_dword v168, v4, s[8:11], s31 offen
    buffer_store_dword v168, v4, s[12:15], s31 offen sc1
    s_sleep 4
    buffer_load_dwordx4 v[212:215], v6, s[16:19], s31 offen sc1
    buffer_load_dwordx4 v[216:219], v6, s[16:19], s60 offen sc1
    buffer_load_dwordx4 v[220:223], v7, s[16:19], 0 offen sc1
    s_branch .poll_31
.miss_32:
    s_sub_u32 s30, s30, 1
    s_cbranch_scc1 .Lfail6
    s_mov_b64 exec, vcc
    buffer_load_dwordx4 v[212:215], v6, s[16:19], s31 offen sc1
    buffer_load_dwordx4 v[216:219], v6, s[16:19], s60 offen sc1
    buffer_load_dwordx4 v[220:223], v7, s[16:19], 0 offen sc1
    s_mov_b64 exec, -1
.poll_31:
    s_waitcnt vmcnt(0)
    v_add_f32_dpp v244, v220, v220 row_ror:1 row_mask:0xf bank_mask:0xf
    v_add_f32_dpp v245, v221, v221 row_ror:1 row_mask:0xf bank_mask:0xf
    v_xor_b32 v228, s70, v212
    v_add_f32_dpp v244, v244, v244 row_ror:2 row_mask:0xf bank_mask:0xf
    v_add_f32_dpp v245, v245, v245 row_ror:2 row_mask:0xf bank_mask:0xf
    v_xor_b32 v229, s70, v213
    v_xor_b32 v230, s70, v214
    v_xor_b32 v231, s70, v215
    v_add_f32_dpp v244, v244, v244 row_ror:4 row_mask:0xf bank_mask:0xf
    v_add_f32_dpp v245, v245, v245 row_ror:4 row_mask:0xf bank_mask:0xf
    v_xor_b32 v232, s70, v216
    v_xor_b32 v233, s70, v217
    v_xor_b32 v234, s70, v218
    v_add_f32_dpp v244, v244, v244 row_ror:8 row_mask:0xf bank_mask:0xf
    v_add_f32_dpp v245, v245, v245 row_ror:8 row_mask:0xf bank_mask:0xf
    v_xor_b32 v235, s70, v219
    v_or3_b32 v240, v228, v229, v230
    v_bitop3_b32 v243, v222, v223, v186 bitop3:0x7e
    v_mul_f32 v244, 0x3b000000, v244
    v_or3_b32 v240, v240, v231, v232
    v_mul_f32 v245, 0x3b000000, v245
    v_or3_b32 v240, v240, v233, v234
    v_fma_f32 v245, -v244, v244, v245
    v_bitop3_b32 v240, v240, v235, v3 bitop3:0xa8
    v_max_f32 v245, 0, v245
    v_or_b32 v240, v240, v243
    v_cmp_ne_u32 vcc, 0, v240
    v_add_f32 v245, 0x3727c5ac, v245
    v_rsq_f32 v245, v245
    v_pk_add_f32 v[236:237], v[228:229], v[232:233]
    v_pk_add_f32 v[238:239], v[230:231], v[234:235]
    s_cbranch_vccnz .miss_32
    s_nop 0
    v_permlane32_swap_b32 v236, v238
    v_permlane32_swap_b32 v237, v239
    v_add_f32 v241, v236, v238
    v_add_f32 v242, v237, v239
    v_fma_f32 v241, -v244, v36, v241
    v_fma_f32 v242, -v244, v37, v242
    v_mul_f32 v241, v245, v241
    v_mul_f32 v242, v245, v242
    v_cvt_pk_bf16_f32 v241, v241, v242
    ds_write_b32 v8, v241 offset:1024
    s_waitcnt lgkmcnt(0)
    s_barrier
    ds_read_b128 v[152:155], v9 offset:1024
    ds_read_b128 v[156:159], v9 offset:1088
    ds_read_b128 v[160:163], v9 offset:1152
    ds_read_b128 v[164:167], v9 offset:1216
    s_waitcnt lgkmcnt(3)
    v_mfma_f32_16x16x32_bf16 v[168:171], v[56:59], v[152:155], 0
    v_mfma_f32_16x16x32_bf16 v[172:175], v[72:75], v[152:155], 0
    s_waitcnt lgkmcnt(2)
    v_mfma_f32_16x16x32_bf16 v[168:171], v[60:63], v[156:159], v[168:171]
    v_mfma_f32_16x16x32_bf16 v[172:175], v[76:79], v[156:159], v[172:175]
    s_waitcnt lgkmcnt(1)
    v_mfma_f32_16x16x32_bf16 v[168:171], v[64:67], v[160:163], v[168:171]
    v_mfma_f32_16x16x32_bf16 v[172:175], v[80:83], v[160:163], v[172:175]
    s_waitcnt lgkmcnt(0)
    v_mfma_f32_16x16x32_bf16 v[168:171], v[68:71], v[164:167], v[168:171]
    v_mfma_f32_16x16x32_bf16 v[172:175], v[84:87], v[164:167], v[172:175]
    s_nop 6
    v_max3_f32 v229, v168, v169, v170
    v_max3_f32 v230, v172, v173, v174
    v_max3_f32 v229, v229, v171, v175
    v_max_f32 v229, v229, v230
    v_mov_b32 v230, v229
    s_nop 1
    v_permlane32_swap_b32 v229, v230
    v_max_f32 v229, v229, v230
    v_mov_b32 v230, v229
    s_nop 1
    v_permlane16_swap_b32 v229, v230
    v_max_f32 v229, v229, v230
    v_mul_f32 v244, s24, v229
    v_fma_f32 v168, v168, s24, -v244
    v_fma_f32 v169, v169, s24, -v244
    v_fma_f32 v170, v170, s24, -v244
    v_fma_f32 v171, v171, s24, -v244
    v_fma_f32 v172, v172, s24, -v244
    v_fma_f32 v173, v173, s24, -v244
    v_fma_f32 v174, v174, s24, -v244
    v_fma_f32 v175, v175, s24, -v244
    v_exp_f32 v168, v168
    v_exp_f32 v169, v169
    v_exp_f32 v170, v170
    v_exp_f32 v171, v171
    v_exp_f32 v172, v172
    v_exp_f32 v173, v173
    v_exp_f32 v174, v174
    v_exp_f32 v175, v175
    s_mov_b64 exec, s[48:49]
    v_cvt_pk_bf16_f32 v196, v168, v169
    v_cvt_pk_bf16_f32 v197, v170, v171
    v_cvt_pk_bf16_f32 v198, v172, v173
    v_cvt_pk_bf16_f32 v199, v174, v175
    s_mov_b64 exec, s[50:51]
    v_cvt_pk_bf16_f32 v200, v168, v169
    v_cvt_pk_bf16_f32 v201, v170, v171
    v_cvt_pk_bf16_f32 v202, v172, v173
    v_cvt_pk_bf16_f32 v203, v174, v175
    s_mov_b64 exec, -1
    v_mfma_f32_16x16x32_bf16 v[188:191], v[88:91], v[196:199], 0
    v_mfma_f32_16x16x32_bf16 v[192:195], v[104:107], v[196:199], 0
    s_mov_b64 exec, s[52:53]
    v_cvt_pk_bf16_f32 v204, v168, v169
    v_cvt_pk_bf16_f32 v205, v170, v171
    v_cvt_pk_bf16_f32 v206, v172, v173
    v_cvt_pk_bf16_f32 v207, v174, v175
    s_mov_b64 exec, -1
    v_mfma_f32_16x16x32_bf16 v[188:191], v[92:95], v[200:203], v[188:191]
    v_mfma_f32_16x16x32_bf16 v[192:195], v[108:111], v[200:203], v[192:195]
    s_mov_b64 exec, s[54:55]
    v_cvt_pk_bf16_f32 v208, v168, v169
    v_cvt_pk_bf16_f32 v209, v170, v171
    v_cvt_pk_bf16_f32 v210, v172, v173
    v_cvt_pk_bf16_f32 v211, v174, v175
    s_mov_b64 exec, -1
    v_mfma_f32_16x16x32_bf16 v[188:191], v[96:99], v[204:207], v[188:191]
    v_mfma_f32_16x16x32_bf16 v[192:195], v[112:115], v[204:207], v[192:195]
    v_pk_add_f32 v[168:169], v[168:169], v[170:171]
    v_pk_add_f32 v[172:173], v[172:173], v[174:175]
    v_pk_add_f32 v[168:169], v[168:169], v[172:173]
    v_add_f32 v245, v168, v169
    v_mfma_f32_16x16x32_bf16 v[188:191], v[100:103], v[208:211], v[188:191]
    v_mfma_f32_16x16x32_bf16 v[192:195], v[116:119], v[208:211], v[192:195]
    v_mov_b32 v229, v245
    s_nop 1
    v_permlane32_swap_b32 v245, v229
    v_add_f32 v245, v245, v229
    v_mov_b32 v229, v245
    s_nop 1
    v_permlane16_swap_b32 v245, v229
    v_add_f32 v245, v245, v229
    ds_write_b64 v11, v[244:245] offset:2176
    ds_write_b128 v10, v[188:191] offset:4608
    ds_write_b128 v10, v[192:195] offset:4864
    s_add_u32 s36, s27, 8
    v_mov_b32 v250, s36
    v_mov_b32 v251, s36
    s_waitcnt lgkmcnt(0)
    s_barrier
    ds_read_b64 v[228:229], v13 offset:2176
    ds_read_b64 v[232:233], v12 offset:4608
    ds_read_b64 v[234:235], v12 offset:6720
    ds_read_b64 v[236:237], v12 offset:8832
    ds_read_b64 v[238:239], v12 offset:10944
    s_waitcnt lgkmcnt(4)
    v_max_f32_dpp v248, v228, v228 quad_perm:[1,0,3,2] row_mask:0xf bank_mask:0xf
    s_nop 1
    v_max_f32_dpp v248, v248, v248 quad_perm:[2,3,0,1] row_mask:0xf bank_mask:0xf
    v_sub_f32 v240, v228, v248
    v_exp_f32 v240, v240
    s_waitcnt lgkmcnt(0)
    v_mul_f32 v249, v240, v229
    v_mul_f32_dpp v242, v240, v232 quad_perm:[0,0,0,0] row_mask:0xf bank_mask:0xf
    v_mul_f32_dpp v243, v240, v233 quad_perm:[0,0,0,0] row_mask:0xf bank_mask:0xf
    v_add_f32_dpp v249, v249, v249 quad_perm:[1,0,3,2] row_mask:0xf bank_mask:0xf
    v_fmac_f32_dpp v242, v240, v234 quad_perm:[1,1,1,1] row_mask:0xf bank_mask:0xf
    v_fmac_f32_dpp v243, v240, v235 quad_perm:[1,1,1,1] row_mask:0xf bank_mask:0xf
    v_add_f32_dpp v249, v249, v249 quad_perm:[2,3,0,1] row_mask:0xf bank_mask:0xf
    v_fmac_f32_dpp v242, v240, v236 quad_perm:[2,2,2,2] row_mask:0xf bank_mask:0xf
    v_fmac_f32_dpp v243, v240, v237 quad_perm:[2,2,2,2] row_mask:0xf bank_mask:0xf
    s_nop 0
    v_fmac_f32_dpp v242, v240, v238 quad_perm:[3,3,3,3] row_mask:0xf bank_mask:0xf
    v_fmac_f32_dpp v243, v240, v239 quad_perm:[3,3,3,3] row_mask:0xf bank_mask:0xf
    v_bfi_b32 v242, v2, v242, s71
    v_bfi_b32 v243, v2, v243, s71
    buffer_store_dwordx2 v[242:243], v14, s[8:11], 0 offen
    buffer_store_dwordx4 v[248:251], v15, s[8:11], 0 offen
    buffer_store_dwordx2 v[242:243], v14, s[12:15], 0 offen sc1
    buffer_store_dwordx4 v[248:251], v15, s[12:15], 0 offen sc1
    s_cmp_lt_u32 s21, 14
    s_cbranch_scc1 .F_33
    s_cmp_lt_u32 s21, 16
    s_cbranch_scc1 .Lexit
    s_sleep 3
    buffer_load_dwordx4 v[212:215], v16, s[16:19], 0 offen sc1
    buffer_load_dwordx4 v[216:219], v17, s[16:19], 0 offen sc1
    s_branch .poll_35
.miss_36:
    s_sub_u32 s30, s30, 1
    s_cbranch_scc1 .Lfail7
    s_mov_b64 exec, vcc
    buffer_load_dwordx4 v[212:215], v16, s[16:19], 0 offen sc1
    buffer_load_dwordx4 v[216:219], v17, s[16:19], 0 offen sc1
    s_mov_b64 exec, -1
.poll_35:
    s_waitcnt vmcnt(0)
    v_max_f32_dpp v232, v216, v216 row_ror:1 row_mask:0xf bank_mask:0xf
    v_xor_b32 v228, s71, v212
    v_xor_b32 v229, s71, v213
    v_max_f32_dpp v232, v232, v232 row_ror:2 row_mask:0xf bank_mask:0xf
    v_xor_b32 v230, s71, v214
    v_xor_b32 v231, s71, v215
    v_max_f32_dpp v232, v232, v232 row_ror:4 row_mask:0xf bank_mask:0xf
    v_or3_b32 v236, v228, v229, v230
    v_bitop3_b32 v236, v236, v231, v3 bitop3:0xa8
    v_max_f32_dpp v232, v232, v232 row_ror:8 row_mask:0xf bank_mask:0xf
    v_bitop3_b32 v237, v218, v219, v250 bitop3:0x7e
    v_mov_b32 v233, v232
    v_or_b32 v236, v236, v237
    v_cmp_ne_u32 vcc, 0, v236
    v_permlane16_swap_b32 v232, v233
    v_max_f32 v232, v232, v233
    v_sub_f32 v232, v216, v232
    v_exp_f32 v232, v232
    s_cbranch_vccnz .miss_36
    v_mul_f32 v234, v232, v217
    v_mul_f32 v228, v232, v228
    v_mul_f32 v229, v232, v229
    v_mul_f32 v230, v232, v230
    v_mul_f32 v231, v232, v231
    v_add_f32_dpp v234, v234, v234 row_ror:1 row_mask:0xf bank_mask:0xf
    v_permlane16_swap_b32 v228, v229
    v_permlane16_swap_b32 v230, v231
    v_add_f32_dpp v234, v234, v234 row_ror:2 row_mask:0xf bank_mask:0xf
    v_add_f32 v228, v228, v229
    v_add_f32 v230, v230, v231
    v_add_f32_dpp v234, v234, v234 row_ror:4 row_mask:0xf bank_mask:0xf
    v_add_f32_dpp v232, v228, v228 row_ror:8 row_mask:0xf bank_mask:0x3
    s_nop 1
    v_add_f32_dpp v232, v230, v230 row_ror:8 row_mask:0xf bank_mask:0xc
    v_add_f32_dpp v234, v234, v234 row_ror:8 row_mask:0xf bank_mask:0xf
    s_nop 0
    v_add_f32_dpp v232, v232, v232 row_half_mirror row_mask:0xf bank_mask:0xf
    v_mov_b32 v233, v234
    s_nop 0
    v_add_f32_dpp v232, v232, v232 quad_perm:[1,0,3,2] row_mask:0xf bank_mask:0xf
    v_permlane16_swap_b32 v234, v233
    v_add_f32 v234, v234, v233
    v_add_f32_dpp v232, v232, v232 quad_perm:[2,3,0,1] row_mask:0xf bank_mask:0xf
    v_rcp_f32 v234, v234
    s_nop 0
    v_mul_f32 v232, v232, v234
    v_cvt_pk_bf16_f32 v232, v232, v232
    ds_write_b16 v18, v232 offset:2304
    s_waitcnt lgkmcnt(0)
    s_barrier
    s_mov_b64 exec, s[48:49]
    ds_read_b128 v[196:199], v28 offset:2304
    s_mov_b64 exec, s[50:51]
    ds_read_b128 v[200:203], v28 offset:2304
    s_mov_b64 exec, s[52:53]
    ds_read_b128 v[204:207], v28 offset:2304
    s_mov_b64 exec, s[54:55]
    ds_read_b128 v[208:211], v28 offset:2304
    s_mov_b64 exec, -1
    s_waitcnt lgkmcnt(3)
    v_mfma_f32_16x16x32_bf16 v[168:171], v[196:199], v[120:123], 0
    v_mfma_f32_16x16x32_bf16 v[172:175], v[196:199], v[136:139], 0
    s_waitcnt lgkmcnt(2)
    v_mfma_f32_16x16x32_bf16 v[168:171], v[200:203], v[124:127], v[168:171]
    v_mfma_f32_16x16x32_bf16 v[172:175], v[200:203], v[140:143], v[172:175]
    s_waitcnt lgkmcnt(1)
    v_mfma_f32_16x16x32_bf16 v[168:171], v[204:207], v[128:131], v[168:171]
    v_mfma_f32_16x16x32_bf16 v[172:175], v[204:207], v[144:147], v[172:175]
    s_waitcnt lgkmcnt(0)
    v_mfma_f32_16x16x32_bf16 v[168:171], v[208:211], v[132:135], v[168:171]
    v_mfma_f32_16x16x32_bf16 v[172:175], v[208:211], v[148:151], v[172:175]
    s_nop 6
    v_bfi_b32 v168, v2, v168, s72
    v_bfi_b32 v172, v2, v172, s72
    buffer_store_dword v168, v20, s[8:11], s4 offen
    buffer_store_dword v172, v20, s[8:11], s5 offen
    buffer_store_dword v168, v20, s[12:15], s4 offen sc1
    buffer_store_dword v172, v20, s[12:15], s5 offen sc1
    s_cmp_lg_u32 s22, 0
    s_cselect_b32 s36, s62, 1
    s_cmp_eq_u32 s36, 0
    s_cbranch_scc1 .Lexit
    s_cmp_lg_u32 s22, 0
    s_cbranch_scc1 .nw_37
    s_sleep 4
    buffer_load_dwordx4 v[212:215], v21, s[16:19], s4 offen sc1
    buffer_load_dwordx4 v[216:219], v21, s[16:19], s4 offen offset:1024 sc1
    s_branch .poll_40
.miss_41:
    s_sub_u32 s30, s30, 1
    s_cbranch_scc1 .Lfail8
    s_mov_b64 exec, vcc
    buffer_load_dwordx4 v[212:215], v21, s[16:19], s4 offen sc1
    buffer_load_dwordx4 v[216:219], v21, s[16:19], s4 offen offset:1024 sc1
    s_mov_b64 exec, -1
.poll_40:
    s_waitcnt vmcnt(0)
    v_xor_b32 v228, s72, v212
    v_xor_b32 v229, s72, v213
    v_xor_b32 v230, s72, v214
    v_xor_b32 v231, s72, v215
    v_xor_b32 v232, s72, v216
    v_xor_b32 v233, s72, v217
    v_xor_b32 v234, s72, v218
    v_xor_b32 v235, s72, v219
    v_pk_add_f32 v[236:237], v[228:229], v[232:233]
    v_pk_add_f32 v[238:239], v[230:231], v[234:235]
    v_or3_b32 v240, v228, v229, v230
    v_or3_b32 v240, v240, v231, v232
    v_permlane32_swap_b32 v236, v237
    v_permlane32_swap_b32 v238, v239
    v_add_f32 v236, v236, v237
    v_add_f32 v238, v238, v239
    v_or3_b32 v240, v240, v233, v234
    v_bitop3_b32 v240, v240, v235, v3 bitop3:0xa8
    v_permlane16_swap_b32 v236, v238
    v_add_f32 v236, v236, v238
    v_cmp_ne_u32 vcc, 0, v240
    s_nop 0
    v_add_f32_dpp v236, v236, v236 row_ror:8 row_mask:0xf bank_mask:0xf
    v_bfi_b32 v236, v2, v236, s73
    s_cbranch_vccnz .miss_41
    buffer_store_dword v236, v24, s[16:19], s58 offen sc1
.nw_37:
    s_cmp_lg_u32 s22, 0
    s_cbranch_scc1 .nw_38
    s_sleep 32
    v_and_b32 v242, s74, v23
    buffer_load_dwordx4 v[212:215], v21, s[16:19], s6 offen sc1
    buffer_load_dwordx4 v[216:219], v22, s[16:19], s6 offen offset:1024 sc1
    s_branch .poll_42
.miss_43:
    s_sub_u32 s30, s30, 1
    s_cbranch_scc1 .Lfail10
    s_mov_b64 exec, vcc
    buffer_load_dwordx4 v[212:215], v21, s[16:19], s6 offen sc1
    buffer_load_dwordx4 v[216:219], v22, s[16:19], s6 offen offset:1024 sc1
    s_mov_b64 exec, -1
.poll_42:
    s_waitcnt vmcnt(0)
    v_xor_b32 v228, s74, v212
    v_xor_b32 v229, s74, v213
    v_xor_b32 v230, s74, v214
    v_xor_b32 v231, s74, v215
    v_xor_b32 v232, v242, v216
    v_xor_b32 v233, v242, v217
    v_xor_b32 v234, v242, v218
    v_xor_b32 v235, v242, v219
    v_pk_add_f32 v[236:237], v[228:229], v[232:233]
    v_pk_add_f32 v[238:239], v[230:231], v[234:235]
    v_or3_b32 v240, v228, v229, v230
    v_or3_b32 v240, v240, v231, v232
    v_permlane32_swap_b32 v236, v237
    v_permlane32_swap_b32 v238, v239
    v_add_f32 v236, v236, v237
    v_add_f32 v238, v238, v239
    v_or3_b32 v240, v240, v233, v234
    v_bitop3_b32 v240, v240, v235, v3 bitop3:0xa8
    v_permlane16_swap_b32 v236, v238
    v_add_f32 v236, v236, v238
    v_cmp_ne_u32 vcc, 0, v240
    s_nop 0
    v_add_f32_dpp v236, v236, v236 row_ror:8 row_mask:0xf bank_mask:0xf
    v_bfi_b32 v236, v2, v236, s75
    s_cbranch_vccnz .miss_43
    buffer_store_dword v236, v24, s[16:19], s59 offen sc1
.nw_38:
    s_cmp_eq_u32 s62, 0
    s_cbranch_scc1 .Lexit
    s_barrier
    s_sleep 6
    s_branch .join_34
.F_33:
    buffer_load_dwordx4 v[212:215], v26, s[16:19], s57 offen offset:0 sc1
    buffer_load_dwordx4 v[216:219], v26, s[16:19], s57 offen offset:512 sc1
    buffer_load_dwordx4 v[220:223], v26, s[16:19], s57 offen offset:1024 sc1
    buffer_load_dwordx4 v[224:227], v26, s[16:19], s57 offen offset:1536 sc1
    s_branch .poll_44
.miss_45:
    s_sub_u32 s30, s30, 1
    s_cbranch_scc1 .Lfail5
    s_mov_b64 exec, vcc
    buffer_load_dwordx4 v[212:215], v26, s[16:19], s57 offen offset:0 sc1
    buffer_load_dwordx4 v[216:219], v26, s[16:19], s57 offen offset:512 sc1
    buffer_load_dwordx4 v[220:223], v26, s[16:19], s57 offen offset:1024 sc1
    buffer_load_dwordx4 v[224:227], v26, s[16:19], s57 offen offset:1536 sc1
    s_mov_b64 exec, -1
.poll_44:
    s_waitcnt vmcnt(0)
    v_xor_b32 v228, s69, v212
    v_xor_b32 v229, s69, v213
    v_xor_b32 v230, s69, v214
    v_xor_b32 v231, s69, v215
    v_xor_b32 v232, s69, v216
    v_xor_b32 v233, s69, v217
    v_xor_b32 v234, s69, v218
    v_xor_b32 v235, s69, v219
    v_xor_b32 v236, s69, v220
    v_xor_b32 v237, s69, v221
    v_xor_b32 v238, s69, v222
    v_xor_b32 v239, s69, v223
    v_xor_b32 v240, s69, v224
    v_xor_b32 v241, s69, v225
    v_xor_b32 v242, s69, v226
    v_xor_b32 v243, s69, v227
    v_pk_add_f32 v[244:245], v[228:229], v[232:233]
    v_pk_add_f32 v[246:247], v[230:231], v[234:235]
    v_pk_add_f32 v[250:251], v[236:237], v[240:241]
    v_pk_add_f32 v[252:253], v[238:239], v[242:243]
    v_pk_add_f32 v[244:245], v[244:245], v[250:251]
    v_pk_add_f32 v[246:247], v[246:247], v[252:253]
    v_or3_b32 v248, v228, v229, v230
    v_or3_b32 v248, v248, v231, v232
    v_permlane32_swap_b32 v244, v246
    v_permlane32_swap_b32 v245, v247
    v_pk_add_f32 v[244:245], v[244:245], v[246:247]
    v_or3_b32 v248, v248, v233, v234
    v_cvt_pk_bf16_f32 v244, v244, v245
    v_or3_b32 v248, v248, v235, v236
    v_and_b32 v245, 0xffff0000, v244
    v_lshlrev_b32 v244, 16, v244
    v_or3_b32 v248, v248, v237, v238
    v_add_f32 v244, v34, v244
    v_add_f32 v245, v35, v245
    v_or3_b32 v248, v248, v239, v240
    v_or3_b32 v248, v248, v241, v242
    v_bitop3_b32 v248, v248, v243, v3 bitop3:0xa8
    v_cmp_ne_u32 vcc, 0, v248
    v_cvt_pk_bf16_f32 v228, v244, v245
    s_cbranch_vccnz .miss_45
    v_lshlrev_b32 v34, 16, v228
    v_and_b32 v35, 0xffff0000, v228
    s_cmp_lg_u32 s22, 0
    s_cbranch_scc1 .nw_46
    buffer_load_dwordx4 v[212:215], v21, s[16:19], s4 offen sc1
    buffer_load_dwordx4 v[216:219], v21, s[16:19], s4 offen offset:1024 sc1
    s_branch .poll_47
.miss_48:
    s_sub_u32 s30, s30, 1
    s_cbranch_scc1 .Lfail8
    s_mov_b64 exec, vcc
    buffer_load_dwordx4 v[212:215], v21, s[16:19], s4 offen sc1
    buffer_load_dwordx4 v[216:219], v21, s[16:19], s4 offen offset:1024 sc1
    s_mov_b64 exec, -1
.poll_47:
    s_waitcnt vmcnt(0)
    v_xor_b32 v228, s72, v212
    v_xor_b32 v229, s72, v213
    v_xor_b32 v230, s72, v214
    v_xor_b32 v231, s72, v215
    v_xor_b32 v232, s72, v216
    v_xor_b32 v233, s72, v217
    v_xor_b32 v234, s72, v218
    v_xor_b32 v235, s72, v219
    v_or3_b32 v240, v228, v229, v230
    v_or3_b32 v240, v240, v231, v232
    v_or3_b32 v240, v240, v233, v234
    v_bitop3_b32 v240, v240, v235, v3 bitop3:0xa8
    v_cmp_ne_u32 vcc, 0, v240
    s_cbranch_vccnz .miss_48
.nw_46:
    s_barrier
    s_sleep 16
    buffer_load_dwordx4 v[212:215], v26, s[16:19], s58 offen offset:0 sc1
    buffer_load_dwordx4 v[216:219], v26, s[16:19], s58 offen offset:512 sc1
    buffer_load_dwordx4 v[220:223], v26, s[16:19], s58 offen offset:1024 sc1
    buffer_load_dwordx4 v[224:227], v26, s[16:19], s58 offen offset:1536 sc1
    s_branch .poll_49
.miss_50:
    s_sub_u32 s30, s30, 1
    s_cbranch_scc1 .Lfail9
    s_mov_b64 exec, vcc
    buffer_load_dwordx4 v[212:215], v26, s[16:19], s58 offen offset:0 sc1
    buffer_load_dwordx4 v[216:219], v26, s[16:19], s58 offen offset:512 sc1
    buffer_load_dwordx4 v[220:223], v26, s[16:19], s58 offen offset:1024 sc1
    buffer_load_dwordx4 v[224:227], v26, s[16:19], s58 offen offset:1536 sc1
    s_mov_b64 exec, -1
.poll_49:
    s_waitcnt vmcnt(0)
    v_xor_b32 v228, s73, v212
    v_xor_b32 v229, s73, v213
    v_xor_b32 v230, s73, v214
    v_xor_b32 v231, s73, v215
    v_xor_b32 v232, s73, v216
    v_xor_b32 v233, s73, v217
    v_xor_b32 v234, s73, v218
    v_xor_b32 v235, s73, v219
    v_xor_b32 v236, s73, v220
    v_xor_b32 v237, s73, v221
    v_xor_b32 v238, s73, v222
    v_xor_b32 v239, s73, v223
    v_xor_b32 v240, s73, v224
    v_xor_b32 v241, s73, v225
    v_xor_b32 v242, s73, v226
    v_xor_b32 v243, s73, v227
    v_pk_add_f32 v[244:245], v[228:229], v[232:233]
    v_pk_add_f32 v[246:247], v[230:231], v[234:235]
    v_pk_add_f32 v[250:251], v[236:237], v[240:241]
    v_pk_add_f32 v[252:253], v[238:239], v[242:243]
    v_pk_add_f32 v[244:245], v[244:245], v[250:251]
    v_pk_add_f32 v[246:247], v[246:247], v[252:253]
    v_or3_b32 v248, v228, v229, v230
    v_or3_b32 v248, v248, v231, v232
    v_permlane32_swap_b32 v244, v246
    v_permlane32_swap_b32 v245, v247
    v_pk_add_f32 v[244:245], v[244:245], v[246:247]
    v_or3_b32 v248, v248, v233, v234
    v_cvt_pk_bf16_f32 v244, v244, v245
    v_or3_b32 v248, v248, v235, v236
    v_and_b32 v245, 0xffff0000, v244
    v_lshlrev_b32 v244, 16, v244
    v_or3_b32 v248, v248, v237, v238
    v_add_f32 v244, v34, v244
    v_add_f32 v245, v35, v245
    v_or3_b32 v248, v248, v239, v240
    v_or3_b32 v248, v248, v241, v242
    v_bitop3_b32 v248, v248, v243, v3 bitop3:0xa8
    v_cmp_ne_u32 vcc, 0, v248
    v_cvt_pk_bf16_f32 v228, v244, v245
    s_cbranch_vccnz .miss_50
    ds_write_b32 v29, v228 offset:0
    v_lshlrev_b32 v34, 16, v228
    v_and_b32 v35, 0xffff0000, v228
    s_lshl_b32 s36, s22, 8
    v_add_u32 v229, s36, v28
    v_add_f32 v230, v34, v35
    v_mul_f32 v231, v34, v34
    v_fmac_f32 v231, v35, v35
    ds_read_b128 v[152:155], v229 offset:0
    ds_read_b128 v[156:159], v229 offset:64
    ds_read_b128 v[160:163], v229 offset:128
    ds_read_b128 v[164:167], v229 offset:192
    v_permlane32_swap_b32 v230, v231
    v_add_f32 v230, v230, v231
    v_mov_b32 v231, v230
    s_nop 1
    v_permlane16_swap_b32 v230, v231
    v_add_f32 v230, v230, v231
    v_or_b32 v232, s73, v34
    s_nop 0
    v_add_f32_dpp v230, v230, v230 row_ror:8 row_mask:0xf bank_mask:0xf
    v_or_b32 v233, s73, v35
    s_nop 0
    v_add_f32_dpp v230, v230, v230 row_ror:4 row_mask:0xf bank_mask:0xf
    v_lshl_add_u32 v234, v29, 1, s79
    s_nop 0
    v_add_f32_dpp v230, v230, v230 row_ror:2 row_mask:0xf bank_mask:0xf
    s_nop 0
    s_nop 0
    v_add_f32_dpp v230, v230, v230 row_ror:1 row_mask:0xf bank_mask:0xf
    s_waitcnt lgkmcnt(3)
    v_mfma_f32_16x16x32_bf16 v[168:171], v[152:155], v[120:123], 0
    s_waitcnt lgkmcnt(2)
    v_mfma_f32_16x16x32_bf16 v[168:171], v[156:159], v[124:127], v[168:171]
    s_waitcnt lgkmcnt(1)
    v_mfma_f32_16x16x32_bf16 v[168:171], v[160:163], v[128:131], v[168:171]
    s_waitcnt lgkmcnt(0)
    v_mfma_f32_16x16x32_bf16 v[168:171], v[164:167], v[132:135], v[168:171]
    buffer_store_dwordx2 v[232:233], v234, s[8:11], s78 offen
    buffer_store_dwordx2 v[232:233], v234, s[12:15], s78 offen sc1
    ds_write_b32 v32, v230 offset:2816
    s_nop 4
    ds_write_b32 v30, v168 offset:2560
    s_waitcnt lgkmcnt(0)
    s_barrier
    ds_read_b128 v[232:235], v19 offset:2816
    ds_read_b128 v[236:239], v19 offset:2832
    ds_read_b128 v[228:231], v31 offset:2560
    s_waitcnt lgkmcnt(1)
    v_pk_add_f32 v[232:233], v[232:233], v[234:235]
    v_pk_add_f32 v[236:237], v[236:237], v[238:239]
    v_add_f32 v232, v232, v233
    v_add_f32 v236, v236, v237
    v_mul_f32 v232, 0x3b000000, v232
    v_mul_f32 v236, 0x3b000000, v236
    v_fma_f32 v236, -v232, v232, v236
    v_max_f32 v236, 0, v236
    v_add_f32 v236, 0x3727c5ac, v236
    v_rsq_f32 v236, v236
    s_waitcnt lgkmcnt(0)
    v_pk_add_f32 v[228:229], v[228:229], v[230:231]
    v_add_f32 v228, v228, v229
    v_fma_f32 v228, -v232, v38, v228
    v_mul_f32 v228, v236, v228
    v_cvt_pk_bf16_f32 v228, 0, v228
    v_mul_f32 v229, 0xbfb8aa3b, v228
    v_exp_f32 v229, v229
    s_nop 0
    v_add_f32 v229, 1.0, v229
    v_rcp_f32 v229, v229
    s_nop 0
    v_mul_f32 v228, v228, v229
    s_nop 1
    v_mov_b32_dpp v229, v228 quad_perm:[1,0,3,2] row_mask:0xf bank_mask:0xf
    v_cvt_pk_bf16_f32 v228, v228, v229
    s_nop 0
    v_readlane_b32 s40, v228, 0
    v_readlane_b32 s41, v228, 2
    v_readlane_b32 s42, v228, 4
    v_readlane_b32 s43, v228, 6
    v_readlane_b32 s44, v228, 8
    v_readlane_b32 s45, v228, 10
    v_readlane_b32 s46, v228, 12
    v_readlane_b32 s47, v228, 14
    v_dot2_f32_bf16 v244, v136, s40, 0
    v_dot2_f32_bf16 v245, v144, s40, 0
    v_dot2_f32_bf16 v244, v137, s41, v244
    v_dot2_f32_bf16 v245, v145, s41, v245
    v_dot2_f32_bf16 v244, v138, s42, v244
    v_dot2_f32_bf16 v245, v146, s42, v245
    v_dot2_f32_bf16 v244, v139, s43, v244
    v_dot2_f32_bf16 v245, v147, s43, v245
    v_dot2_f32_bf16 v244, v140, s44, v244
    v_dot2_f32_bf16 v245, v148, s44, v245
    v_dot2_f32_bf16 v244, v141, s45, v244
    v_dot2_f32_bf16 v245, v149, s45, v245
    v_dot2_f32_bf16 v244, v142, s46, v244
    v_dot2_f32_bf16 v245, v150, s46, v245
    v_dot2_f32_bf16 v244, v143, s47, v244
    v_dot2_f32_bf16 v245, v151, s47, v245
    s_nop 1
    v_bfi_b32 v244, v2, v244, s74
    v_bfi_b32 v245, v2, v245, s74
    buffer_store_dword v244, v20, s[8:11], s6 offen
    buffer_store_dword v245, v20, s[8:11], s7 offen
    buffer_store_dword v244, v20, s[12:15], s6 offen sc1
    buffer_store_dword v245, v20, s[12:15], s7 offen sc1
    s_branch .Lexit
.join_34:
    buffer_load_dwordx4 v[212:215], v25, s[16:19], s59 offen sc1
    buffer_load_dword v216, v33, s[16:19], s78 offen sc1
    s_branch .poll_51
.miss_52:
    s_sub_u32 s30, s30, 1
    s_cbranch_scc1 .Lfail11
    s_mov_b64 exec, vcc
    buffer_load_dwordx4 v[212:215], v25, s[16:19], s59 offen sc1
    buffer_load_dword v216, v33, s[16:19], s78 offen sc1
    s_mov_b64 exec, -1
.poll_51:
    s_waitcnt vmcnt(0)
    v_xor_b32 v228, s75, v212
    v_xor_b32 v229, s75, v213
    v_xor_b32 v230, s75, v214
    v_xor_b32 v231, s75, v215
    v_xor_b32 v233, s73, v216
    v_or3_b32 v232, v228, v229, v230
    v_bitop3_b32 v232, v232, v231, v3 bitop3:0xa8
    v_permlane32_swap_b32 v228, v229
    v_permlane32_swap_b32 v230, v231
    v_add_f32 v228, v228, v229
    v_add_f32 v230, v230, v231
    v_lshl_or_b32 v232, v233, 16, v232
    v_cmp_ne_u32 vcc, 0, v232
    v_permlane16_swap_b32 v228, v230
    v_add_f32 v228, v228, v230
    s_nop 1
    v_add_f32_dpp v228, v228, v228 row_ror:8 row_mask:0xf bank_mask:0xf
    v_cvt_pk_bf16_f32 v228, 0, v228
    v_add_f32 v228, v233, v228
    s_cbranch_vccnz .miss_52
    v_cvt_pk_bf16_f32 v33, 0, v228
    s_mov_b32 s88, s80
    s_mov_b32 s89, s81
    s_mov_b32 s90, 0x400
    s_mov_b32 s91, 0x20000
    v_and_b32 v229, 0x80000000, v24
    v_or_b32 v228, v255, v229
    buffer_store_short_d16_hi v33, v228, s[88:91], 0 offen
    s_or_b32 s36, s23, s22
    s_cbranch_scc1 .Lexit
    s_add_u32 s36, s27, 16
    v_mov_b32 v230, s36
    v_and_b32 v231, 0x80000000, v5
    buffer_store_dword v230, v231, s[16:19], 0 offen
.Lexit:
    s_waitcnt vmcnt(0)
    s_endpgm
.Lfail0:
    s_movk_i32 s36, 1
    s_branch .Lfail
.Lfail1:
    s_movk_i32 s36, 2
    s_branch .Lfail
.Lfail2:
    s_movk_i32 s36, 3
    s_branch .Lfail
.Lfail3:
    s_movk_i32 s36, 4
    s_branch .Lfail
.Lfail4:
    s_movk_i32 s36, 5
    s_branch .Lfail
.Lfail5:
    s_movk_i32 s36, 6
    s_branch .Lfail
.Lfail6:
    s_movk_i32 s36, 7
    s_branch .Lfail
.Lfail7:
    s_movk_i32 s36, 8
    s_branch .Lfail
.Lfail8:
    s_movk_i32 s36, 9
    s_branch .Lfail
.Lfail9:
    s_movk_i32 s36, 10
    s_branch .Lfail
.Lfail10:
    s_movk_i32 s36, 11
    s_branch .Lfail
.Lfail11:
    s_movk_i32 s36, 12
    s_branch .Lfail
.Lfail12:
    s_movk_i32 s36, 13
    s_branch .Lfail
.Lfail:
    s_mov_b32 s88, s82
    s_mov_b32 s89, s83
    s_mov_b32 s90, 0x100
    s_mov_b32 s91, 0x20000
    v_mov_b32 v228, s36
    v_lshlrev_b32 v229, 2, v228
    v_mov_b32 v228, s2
    buffer_store_dword v228, v229, s[88:91], 0 offen
    s_branch .Lexit
.Lend:
    s_endpgm
.section .rodata,"a"
.p2align 6
.amdhsa_kernel interleave_layers__sliding_block_cached__dense_activation_silu__decode_kernel
  .amdhsa_next_free_vgpr 256
  .amdhsa_next_free_sgpr 102
  .amdhsa_accum_offset 256
  .amdhsa_group_segment_fixed_size 0
  .amdhsa_kernarg_size 88
  .amdhsa_user_sgpr_count 2
  .amdhsa_user_sgpr_kernarg_segment_ptr 1
  .amdhsa_system_sgpr_workgroup_id_x 1
.end_amdhsa_kernel
```
